```python
import torch

def _softmax(x, axis=-1):
    return torch.softmax(x, dim=axis)
def _gelu(x):
    return torch.nn.functional.gelu(x, approximate="tanh")
def _silu(x):
    return torch.nn.functional.silu(x)
def _sigmoid(x):
    return torch.sigmoid(x)
def _layernorm(x, axis=-1, eps=1e-5):
    m = x.mean(dim=axis, keepdim=True)
    v = x.var(dim=axis, keepdim=True, unbiased=False)
    return (x - m) / torch.sqrt(v + eps)
def _scatter_add(tgt, idx, src, axis=0):
    return tgt.clone().index_add_(axis, idx, src)
def _segment_sum(src, seg, n):
    out = torch.zeros((n,) + src.shape[1:], dtype=src.dtype)
    return out.index_add_(0, seg, src)
def _pad(x, pw):
    flat = tuple(v for pair in reversed(pw) for v in pair)
    return torch.nn.functional.pad(x, flat)

kernel_name = 'concat_heads__grouped_kv_mqa__spectral_fnet__prompt'

def setup_inputs():

    _w = (lambda a: (lambda t: t.to(torch.bfloat16) if t.is_floating_point() else t)(torch.as_tensor(a)))
    def _A_setup():
        B, S, D, H = 1, 2048, 576, 32
        Dh = D // H
        return {
            "x": _w((lambda *s: torch.randn(*s, dtype=torch.bfloat16) * 0.05)(B, S, D)),
            "wq": _w((lambda *s: torch.randn(*s, dtype=torch.bfloat16) * 3.2)(D, H * Dh)),
            "wk": _w((lambda *s: torch.randn(*s, dtype=torch.bfloat16) * 3.2)(D, Dh)),
            "wv": _w((lambda *s: torch.randn(*s, dtype=torch.bfloat16) * 0.4)(D, Dh)),
            "wo": _w((lambda *s: torch.randn(*s, dtype=torch.bfloat16) * 0.4)(H * Dh, D)),
        }
    _A_in = _A_setup()

    def _B_setup():
        B, S, D = 1, 2048, 576
        ns = torch.arange(S)[:, None] * torch.arange(S)[None, :]
        nd = torch.arange(D)[:, None] * torch.arange(D)[None, :]
        Ws_re = torch.cos(-2.0 * torch.pi * ns / S).to(float)
        Ws_im = torch.sin(-2.0 * torch.pi * ns / S).to(float)
        Wd_re = torch.cos(-2.0 * torch.pi * nd / D).to(float)
        Wd_im = torch.sin(-2.0 * torch.pi * nd / D).to(float)
        return {
            "x": _w((lambda *s: torch.randn(*s, dtype=torch.bfloat16) * 0.05)(B, S, D)),
            "dft_seq_re": _w(Ws_re),
            "dft_seq_im": _w(Ws_im),
            "dft_hid_re": _w(Wd_re),
            "dft_hid_im": _w(Wd_im),
        }
    _B_in = _B_setup()

    return {
        "A_x": _A_in["x"],
        "A_wq": _A_in["wq"],
        "A_wk": _A_in["wk"],
        "A_wv": _A_in["wv"],
        "A_wo": _A_in["wo"],
        "B_x": _B_in["x"],
        "B_dft_seq_re": _B_in["dft_seq_re"],
        "B_dft_seq_im": _B_in["dft_seq_im"],
        "B_dft_hid_re": _B_in["dft_hid_re"],
        "B_dft_hid_im": _B_in["dft_hid_im"],
    }

def reference(A_x, A_wq, A_wk, A_wv, A_wo, B_x, B_dft_seq_re, B_dft_seq_im, B_dft_hid_re, B_dft_hid_im):
    def _A_ref(x, wq, wk, wv, wo):
        B, S, D = x.shape
        H = 32
        Dh = D // H
        q = (lambda x, *d: x.permute(*d))((x @ wq).reshape(B, S, H, Dh), 0, 2, 1, 3)
        k = x @ wk
        v = x @ wv
        scores = torch.einsum("bhqd,bkd->bhqk", q, k) * (Dh ** -0.5)
        p = _softmax(scores, axis=-1)
        o = torch.einsum("bhqk,bkd->bhqd", p, v)
        return (lambda x, *d: x.permute(*d))(o, 0, 2, 1, 3).reshape(B, S, H * Dh) @ wo

    def _B_ref(x, dft_seq_re, dft_seq_im, dft_hid_re, dft_hid_im):
        a = torch.einsum("bsd,ed->bse", x, dft_hid_re)
        b = torch.einsum("bsd,ed->bse", x, dft_hid_im)
        y = torch.einsum("ts,bse->bte", dft_seq_re, a) - torch.einsum("ts,bse->bte", dft_seq_im, b)
        return y

    a = _A_ref(A_x, A_wq, A_wk, A_wv, A_wo)
    b = _B_ref(B_x, B_dft_seq_re, B_dft_seq_im, B_dft_hid_re, B_dft_hid_im)
    return torch.concatenate([a, b], axis=-1)
```

```asm
; @launch grid=(256,1,1) block=(512,1,1) lds=160896
.amdgcn_target "amdgcn-amd-amdhsa--gfx950"
.text
.globl concat_heads__grouped_kv_mqa__spectral_fnet__prompt_kernel
.p2align 8
.type concat_heads__grouped_kv_mqa__spectral_fnet__prompt_kernel,@function
concat_heads__grouped_kv_mqa__spectral_fnet__prompt_kernel:

    s_cmp_ge_u32 s2, 256
    s_cbranch_scc1 L_at_end
    s_load_dwordx8 s[68:75], s[0:1], 0
    s_load_dwordx2 s[4:5], s[0:1], 96
    s_load_dwordx4 s[76:79], s[0:1], 32
    s_load_dwordx4 s[60:63], s[0:1], 48
    s_load_dwordx4 s[96:99], s[0:1], 64
    s_load_dwordx2 s[6:7], s[0:1], 80
    v_and_b32 v1, 63, v0
    v_lshrrev_b32 v2, 6, v0
    v_lshrrev_b32 v3, 5, v1
    v_readfirstlane_b32 s12, v2
    v_and_b32 v2, 31, v1
    v_lshlrev_b32 v4, 4, v1
    v_lshlrev_b32 v5, 3, v1
    v_mov_b32 v223, 0
    v_mov_b32 v219, 0
    s_and_b32 s13, s2, 7
    s_lshl_b32 s13, s13, 8
    s_and_b32 s14, s2, 0xf8
    s_add_u32 s13, s13, s14
    s_lshr_b32 s36, s13, 6
    s_bfe_u32 s37, s13, 0x30003
    s_lshr_b32 s26, s37, 1
    s_and_b32 s38, s37, 1
    s_and_b32 s27, s36, 3
    s_lshl_b32 s27, s27, 1
    s_add_u32 s27, s27, s37
    s_cmp_ge_u32 s27, 9
    s_cselect_b32 s24, 9, 0
    s_sub_u32 s27, s27, s24
    v_lshrrev_b32 v97, 2, v1
    v_and_b32 v99, 3, v1
    v_mul_u32_u24 v88, 1152, v97
    v_lshl_add_u32 v89, v99, 4, v88
    v_lshrrev_b32 v100, 4, v1
    v_xor_b32 v100, v100, v99
    v_lshl_add_u32 v88, v100, 4, v88
    v_mul_u32_u24 v90, 36, v97
    v_lshl_add_u32 v90, v99, 4, v90
    v_mov_b32 v101, 1073741824
    v_cmp_eq_u32 vcc, 3, v99
    s_sub_u32 s34, s12, 5
    s_cmp_ge_u32 s26, 2
    s_cselect_b64 s[30:31], -1, 0
    v_cndmask_b32 v90, v90, v101, vcc
    v_cndmask_b32 v90, v89, v90, s[30:31]
    s_lshl_b32 s40, s36, 1
    s_add_u32 s41, s40, s38
    s_mul_i32 s41, s41, 36864
    s_lshl_b32 s44, s26, 6
    s_add_u32 s44, s44, 1024
    s_cmp_ge_u32 s26, 2
    s_cselect_b32 s44, 0, s44
    s_movk_i32 s17, 576
    s_cselect_b32 s45, s17, 18432
    s_mul_i32 s46, s38, 36864
    s_add_u32 s47, s27, s34
    s_cmp_ge_u32 s47, 9
    s_cselect_b32 s24, 9, 0
    s_sub_u32 s47, s47, s24
    s_lshl_b32 s23, s34, 12
    v_mov_b32 v101, 160832
    ds_write_b32 v101, v223 offset:0
    ds_write_b32 v101, v223 offset:4
    ds_write_b32 v101, v223 offset:12
    ds_write_b32 v101, v223 offset:16
    ds_write_b32 v101, v223 offset:20
    ds_write_b32 v101, v223 offset:24
    v_lshlrev_b32 v209, 2, v2
    s_lshl_b32 s24, s12, 7
    s_add_u32 s24, s24, 159744
    v_add_u32 v209, s24, v209
    v_mov_b32 v210, 0xff800000
    ds_write_b32 v209, v210
    v_mov_b32 v212, 160768
    ds_write_b32 v212, v223
    s_lshl_b32 s24, s12, 2
    s_add_u32 s24, s24, 160800
    v_mov_b32 v212, s24
    ds_write_b32 v212, v223
    ds_write_b32 v212, v223 offset:64
    s_waitcnt lgkmcnt(0)
    s_mov_b32 s8, s4
    s_mov_b32 s9, s5
    s_mov_b32 s10, 12582912
    s_mov_b32 s11, 0x00020000
    s_cmp_lt_u32 s12, 4
    s_cbranch_scc1 L_p1_main
    s_cmp_eq_u32 s12, 4
    s_cbranch_scc1 L_p1_w4
    s_mov_b32 s48, s68
    s_mov_b32 s49, s69
    s_mov_b32 s50, 2359296
    s_mov_b32 s51, 0x00020000
    s_cmp_eq_u32 s26, 3
    s_cselect_b32 s64, s74, s72
    s_cselect_b32 s65, s75, s73
    s_mov_b32 s66, 663552
    s_cmp_ge_u32 s26, 2
    s_cselect_b32 s64, s64, s70
    s_cselect_b32 s65, s65, s71
    s_cselect_b32 s66, 20736, s66
    s_mov_b32 s67, 0x00020000
    s_lshl_b32 s15, s47, 7
    s_add_u32 s15, s15, s41
    s_mul_i32 s16, s47, s45
    s_lshl_b32 s16, s16, 2
    s_add_u32 s16, s16, s44
    s_add_u32 s17, s46, s23
    s_add_u32 m0, s17, 0
    s_add_u32 s24, s15, 0
    buffer_load_dwordx4 v88, s[48:51], s24 offen offset:0 lds
    s_add_u32 m0, s23, 73728
    s_nop 0
    buffer_load_dwordx4 v90, s[64:67], s16 offen lds
    s_add_u32 m0, s17, 1024
    s_add_u32 s24, s15, 18432
    buffer_load_dwordx4 v88, s[48:51], s24 offen offset:0 lds
    s_add_u32 m0, s23, 74752
    s_add_u32 s16, s16, s45
    buffer_load_dwordx4 v90, s[64:67], s16 offen lds
    s_add_u32 m0, s17, 1984
    s_add_u32 s24, s15, 0
    buffer_load_dwordx4 v88, s[48:51], s24 offen offset:64 lds
    s_add_u32 m0, s23, 75776
    s_add_u32 s16, s16, s45
    buffer_load_dwordx4 v90, s[64:67], s16 offen lds
    s_add_u32 m0, s17, 3008
    s_add_u32 s24, s15, 18432
    buffer_load_dwordx4 v88, s[48:51], s24 offen offset:64 lds
    s_add_u32 m0, s23, 76800
    s_add_u32 s16, s16, s45
    buffer_load_dwordx4 v90, s[64:67], s16 offen lds
    s_add_u32 s47, s47, 3
    s_cmp_ge_u32 s47, 9
    s_cselect_b32 s24, 9, 0
    s_sub_u32 s47, s47, s24
    s_lshl_b32 s15, s47, 7
    s_add_u32 s15, s15, s41
    s_mul_i32 s16, s47, s45
    s_lshl_b32 s16, s16, 2
    s_add_u32 s16, s16, s44
    s_add_u32 s17, s46, s23
    s_add_u32 m0, s17, 12288
    s_add_u32 s24, s15, 0
    buffer_load_dwordx4 v88, s[48:51], s24 offen offset:0 lds
    s_add_u32 m0, s23, 86016
    s_nop 0
    buffer_load_dwordx4 v90, s[64:67], s16 offen lds
    s_add_u32 m0, s17, 13312
    s_add_u32 s24, s15, 18432
    buffer_load_dwordx4 v88, s[48:51], s24 offen offset:0 lds
    s_add_u32 m0, s23, 87040
    s_add_u32 s16, s16, s45
    buffer_load_dwordx4 v90, s[64:67], s16 offen lds
    s_add_u32 m0, s17, 14272
    s_add_u32 s24, s15, 0
    buffer_load_dwordx4 v88, s[48:51], s24 offen offset:64 lds
    s_add_u32 m0, s23, 88064
    s_add_u32 s16, s16, s45
    buffer_load_dwordx4 v90, s[64:67], s16 offen lds
    s_add_u32 m0, s17, 15296
    s_add_u32 s24, s15, 18432
    buffer_load_dwordx4 v88, s[48:51], s24 offen offset:64 lds
    s_add_u32 m0, s23, 89088
    s_add_u32 s16, s16, s45
    buffer_load_dwordx4 v90, s[64:67], s16 offen lds
    s_add_u32 s47, s47, 3
    s_cmp_ge_u32 s47, 9
    s_cselect_b32 s24, 9, 0
    s_sub_u32 s47, s47, s24
    s_xor_b32 s15, s38, 1
    s_add_u32 s16, s40, s15
    s_mul_i32 s16, s16, 36864
    s_mul_i32 s15, s15, 36864
    s_lshl_b32 s17, s37, 7
    s_lshl_b32 s24, s34, 6
    s_add_u32 s17, s17, s24
    s_sub_u32 s17, s17, 64
    s_add_u32 s25, s23, 106496
    s_mov_b32 s54, 663552
    s_mov_b32 s33, 36864
    s_mov_b32 s32, 73728
    s_cmp_eq_u32 s34, 0
    s_cselect_b64 vcc, -1, 0
    s_cselect_b32 s40, s16, s17
    s_cselect_b32 s42, s15, s25
    s_cselect_b32 s43, 64, s33
    s_cselect_b32 s32, 128, s32
    s_movk_i32 s24, 4096
    s_cselect_b32 s33, s24, 8192
    s_cselect_b32 s14, 0, 49152
    s_cselect_b32 s52, s68, s70
    s_cselect_b32 s53, s69, s71
    s_cselect_b32 s54, 2359296, s54
    s_mov_b32 s55, 0x00020000
    v_cndmask_b32 v94, v89, v88, vcc
    s_waitcnt vmcnt(8)
    s_barrier
    s_lshl_b32 s15, s47, 7
    s_add_u32 s15, s15, s41
    s_mul_i32 s16, s47, s45
    s_lshl_b32 s16, s16, 2
    s_add_u32 s16, s16, s44
    s_add_u32 s17, s46, s23
    s_add_u32 m0, s17, 24576
    s_add_u32 s24, s15, 0
    buffer_load_dwordx4 v88, s[48:51], s24 offen offset:0 lds
    s_add_u32 m0, s23, 98304
    s_nop 0
    buffer_load_dwordx4 v90, s[64:67], s16 offen lds
    s_add_u32 m0, s17, 25600
    s_add_u32 s24, s15, 18432
    buffer_load_dwordx4 v88, s[48:51], s24 offen offset:0 lds
    s_add_u32 m0, s23, 99328
    s_add_u32 s16, s16, s45
    buffer_load_dwordx4 v90, s[64:67], s16 offen lds
    s_add_u32 m0, s17, 26560
    s_add_u32 s24, s15, 0
    buffer_load_dwordx4 v88, s[48:51], s24 offen offset:64 lds
    s_add_u32 m0, s23, 100352
    s_add_u32 s16, s16, s45
    buffer_load_dwordx4 v90, s[64:67], s16 offen lds
    s_add_u32 m0, s17, 27584
    s_add_u32 s24, s15, 18432
    buffer_load_dwordx4 v88, s[48:51], s24 offen offset:64 lds
    s_add_u32 m0, s23, 101376
    s_add_u32 s16, s16, s45
    buffer_load_dwordx4 v90, s[64:67], s16 offen lds
    s_add_u32 s47, s47, 3
    s_cmp_ge_u32 s47, 9
    s_cselect_b32 s24, 9, 0
    s_sub_u32 s47, s47, s24
    s_mul_i32 s15, s27, s32
    s_add_u32 s15, s15, s40
    s_add_u32 m0, s42, 0
    s_add_u32 s16, s15, s43
    buffer_load_dwordx4 v94, s[52:55], s15 offen lds
    s_add_u32 m0, s42, 1024
    s_add_u32 s24, s15, 18432
    buffer_load_dwordx4 v94, s[52:55], s24 offen lds
    s_add_u32 m0, s42, 2048
    s_nop 0
    buffer_load_dwordx4 v94, s[52:55], s16 offen lds
    s_add_u32 m0, s42, 3072
    s_add_u32 s24, s16, 18432
    buffer_load_dwordx4 v94, s[52:55], s24 offen lds
    s_add_u32 s42, s42, s33
    s_add_u32 s27, s27, 1
    s_cmp_eq_u32 s27, 9
    s_cselect_b32 s27, 0, s27
    s_waitcnt vmcnt(12)
    s_barrier
    s_mul_i32 s15, s27, s32
    s_add_u32 s15, s15, s40
    s_add_u32 m0, s42, 0
    s_add_u32 s16, s15, s43
    buffer_load_dwordx4 v94, s[52:55], s15 offen lds
    s_add_u32 m0, s42, 1024
    s_add_u32 s24, s15, 18432
    buffer_load_dwordx4 v94, s[52:55], s24 offen lds
    s_add_u32 m0, s42, 2048
    s_nop 0
    buffer_load_dwordx4 v94, s[52:55], s16 offen lds
    s_add_u32 m0, s42, 3072
    s_add_u32 s24, s16, 18432
    buffer_load_dwordx4 v94, s[52:55], s24 offen lds
    s_add_u32 s42, s42, s33
    s_add_u32 s27, s27, 1
    s_cmp_eq_u32 s27, 9
    s_cselect_b32 s27, 0, s27
    s_waitcnt vmcnt(8)
    s_barrier
    s_mul_i32 s15, s27, s32
    s_add_u32 s15, s15, s40
    s_add_u32 m0, s42, 0
    s_add_u32 s16, s15, s43
    buffer_load_dwordx4 v94, s[52:55], s15 offen lds
    s_add_u32 m0, s42, 1024
    s_add_u32 s24, s15, 18432
    buffer_load_dwordx4 v94, s[52:55], s24 offen lds
    s_add_u32 m0, s42, 2048
    s_nop 0
    buffer_load_dwordx4 v94, s[52:55], s16 offen lds
    s_add_u32 m0, s42, 3072
    s_add_u32 s24, s16, 18432
    buffer_load_dwordx4 v94, s[52:55], s24 offen lds
    s_add_u32 s42, s42, s33
    s_add_u32 s27, s27, 1
    s_cmp_eq_u32 s27, 9
    s_cselect_b32 s27, 0, s27
    s_mov_b32 s56, s78
    s_mov_b32 s57, s79
    s_mov_b32 s58, 2359296
    s_mov_b32 s59, 0x00020000
    v_mov_b32 v120, 0
    v_mov_b32 v121, 0
    v_mov_b32 v122, 0
    v_mov_b32 v123, 0
    v_mov_b32 v124, 0
    v_mov_b32 v125, 0
    s_mov_b32 s39, 0
    s_sub_u32 s24, 7, s12
    s_cmp_gt_u32 s24, 1
    s_cbranch_scc1 L_lt_x
    s_mul_i32 s28, s12, 17920
    s_add_u32 s28, s28, 16384
    s_lshl_b32 s24, s24, 8
    s_add_u32 s24, s24, s2
    s_cmp_ge_u32 s24, 384
    s_cbranch_scc1 L_lt_x
    v_lshrrev_b32 v128, 2, v1
    v_and_b32 v129, 3, v1
    s_cmp_ge_u32 s24, 324
    s_cbranch_scc1 L_lt_hid
    s_mul_hi_u32 s18, s24, 477218589
    s_mul_i32 s19, s18, 9
    s_sub_u32 s19, s24, s19
    s_and_b32 s20, s18, 1
    s_lshr_b32 s21, s18, 1
    s_lshl_b32 s22, s21, 5
    s_add_u32 s22, s22, s20
    v_lshl_add_u32 v128, v128, 1, s22
    s_lshl_b32 s22, s19, 6
    v_lshl_add_u32 v129, v129, 4, s22
    v_mul_u32_u24 v130, 1152, v128
    v_add_u32 v120, v130, v129
    v_sub_u32 v121, v129, v130
    v_add_u32 v122, 1179648, v121
    v_add_u32 v121, 2359296, v121
    v_add_u32 v123, 1179648, v120
    v_mov_b32 v130, 1073741824
    v_cmp_lt_u32 vcc, 512, v128
    s_movk_i32 s22, 512
    v_cmp_le_u32 s[30:31], s22, v128
    v_cmp_eq_u32 s[56:57], 0, v128
    s_mul_i32 s29, s20, 9
    v_cndmask_b32 v120, v120, v130, vcc
    v_cndmask_b32 v121, v121, v130, vcc
    v_cndmask_b32 v122, v122, v130, s[30:31]
    v_cndmask_b32 v123, v123, v130, s[30:31]
    v_cndmask_b32 v123, v123, v130, s[56:57]
    s_lshr_b32 s22, s21, 1
    s_add_u32 s29, s29, s22
    s_mul_i32 s29, s29, 18432
    s_lshl_b32 s22, s19, 11
    s_add_u32 s29, s29, s22
    s_and_b32 s22, s21, 1
    s_lshl_b32 s22, s22, 8
    s_add_u32 s29, s29, s22
    v_and_b32 v126, 15, v1
    v_and_b32 v124, 0x13, v126
    v_bfe_u32 v125, v126, 2, 1
    v_lshl_or_b32 v124, v125, 3, v124
    v_bfe_u32 v125, v126, 3, 1
    v_lshl_or_b32 v124, v125, 2, v124
    v_lshrrev_b32 v125, 4, v1
    v_lshl_add_u32 v124, v124, 2, v125
    v_lshlrev_b32 v124, 4, v124
    v_add_u32 v124, s28, v124
    v_lshlrev_b32 v125, 9, v125
    v_lshl_add_u32 v125, v126, 4, v125
    s_mov_b32 s56, s78
    s_mov_b32 s57, s79
    s_mov_b32 s58, 2359296
    s_mov_b32 s59, 0x00020000
    s_mov_b32 s39, 1
    s_branch L_lt_x
L_lt_hid:
    s_sub_u32 s24, s24, 324
    s_mul_hi_u32 s18, s24, 1431655766
    s_mul_i32 s19, s18, 3
    s_sub_u32 s19, s24, s19
    s_mul_hi_u32 s20, s18, 858993460
    s_mul_i32 s21, s20, 5
    s_sub_u32 s21, s18, s21
    s_lshl_b32 s21, s21, 6
    s_and_b32 s22, s20, 1
    s_add_u32 s21, s21, s22
    v_mul_u32_u24 v120, 2304, v128
    v_lshl_add_u32 v120, v129, 4, v120
    s_mul_i32 s21, s21, 1152
    s_mul_i32 s22, s19, 192
    s_add_u32 s21, s21, s22
    s_add_u32 s22, s21, 36864
    s_mul_i32 s29, s24, 6144
    s_add_u32 s29, s29, 9895936
    v_lshlrev_b32 v124, 6, v2
    v_lshl_add_u32 v124, v3, 4, v124
    v_add_u32 v124, s28, v124
    s_cmp_ge_u32 s20, 2
    s_cselect_b32 s56, s98, s96
    s_cselect_b32 s57, s99, s97
    s_mov_b32 s58, 663552
    s_mov_b32 s59, 0x00020000
    s_mov_b32 s39, 2
L_lt_x:
    s_waitcnt vmcnt(8)
    s_barrier
    s_mul_i32 s15, s27, s32
    s_add_u32 s15, s15, s40
    s_add_u32 m0, s42, 0
    s_add_u32 s16, s15, s43
    buffer_load_dwordx4 v94, s[52:55], s15 offen lds
    s_add_u32 m0, s42, 1024
    s_add_u32 s24, s15, 18432
    buffer_load_dwordx4 v94, s[52:55], s24 offen lds
    s_add_u32 m0, s42, 2048
    s_nop 0
    buffer_load_dwordx4 v94, s[52:55], s16 offen lds
    s_add_u32 m0, s42, 3072
    s_add_u32 s24, s16, 18432
    buffer_load_dwordx4 v94, s[52:55], s24 offen lds
    s_add_u32 s42, s42, s33
    s_add_u32 s27, s27, 1
    s_cmp_eq_u32 s27, 9
    s_cselect_b32 s27, 0, s27
    s_waitcnt vmcnt(8)
    s_barrier
    s_mul_i32 s15, s27, s32
    s_add_u32 s15, s15, s40
    s_add_u32 m0, s42, 0
    s_add_u32 s16, s15, s43
    buffer_load_dwordx4 v94, s[52:55], s15 offen lds
    s_add_u32 m0, s42, 1024
    s_add_u32 s24, s15, 18432
    buffer_load_dwordx4 v94, s[52:55], s24 offen lds
    s_add_u32 m0, s42, 2048
    s_nop 0
    buffer_load_dwordx4 v94, s[52:55], s16 offen lds
    s_add_u32 m0, s42, 3072
    s_add_u32 s24, s16, 18432
    buffer_load_dwordx4 v94, s[52:55], s24 offen lds
    s_add_u32 s42, s42, s33
    s_add_u32 s27, s27, 1
    s_cmp_eq_u32 s27, 9
    s_cselect_b32 s27, 0, s27
    s_waitcnt vmcnt(8)
    s_barrier
    s_mul_i32 s15, s27, s32
    s_add_u32 s15, s15, s40
    s_add_u32 m0, s42, 0
    s_add_u32 s16, s15, s43
    buffer_load_dwordx4 v94, s[52:55], s15 offen lds
    s_add_u32 m0, s42, 1024
    s_add_u32 s24, s15, 18432
    buffer_load_dwordx4 v94, s[52:55], s24 offen lds
    s_add_u32 m0, s42, 2048
    s_nop 0
    buffer_load_dwordx4 v94, s[52:55], s16 offen lds
    s_add_u32 m0, s42, 3072
    s_add_u32 s24, s16, 18432
    buffer_load_dwordx4 v94, s[52:55], s24 offen lds
    s_add_u32 s42, s42, s33
    s_add_u32 s27, s27, 1
    s_cmp_eq_u32 s27, 9
    s_cselect_b32 s27, 0, s27
    s_waitcnt vmcnt(8)
    s_barrier
    s_mul_i32 s15, s27, s32
    s_add_u32 s15, s15, s40
    s_sub_u32 s42, s42, s14
    s_add_u32 m0, s42, 0
    s_add_u32 s16, s15, s43
    buffer_load_dwordx4 v94, s[52:55], s15 offen lds
    s_add_u32 m0, s42, 1024
    s_add_u32 s24, s15, 18432
    buffer_load_dwordx4 v94, s[52:55], s24 offen lds
    s_add_u32 m0, s42, 2048
    s_nop 0
    buffer_load_dwordx4 v94, s[52:55], s16 offen lds
    s_add_u32 m0, s42, 3072
    s_add_u32 s24, s16, 18432
    buffer_load_dwordx4 v94, s[52:55], s24 offen lds
    s_add_u32 s42, s42, s33
    s_add_u32 s27, s27, 1
    s_cmp_eq_u32 s27, 9
    s_cselect_b32 s27, 0, s27
    s_waitcnt vmcnt(8)
    s_barrier
    s_mul_i32 s15, s27, s32
    s_add_u32 s15, s15, s40
    s_add_u32 m0, s42, 0
    s_add_u32 s16, s15, s43
    buffer_load_dwordx4 v94, s[52:55], s15 offen lds
    s_add_u32 m0, s42, 1024
    s_add_u32 s24, s15, 18432
    buffer_load_dwordx4 v94, s[52:55], s24 offen lds
    s_add_u32 m0, s42, 2048
    s_nop 0
    buffer_load_dwordx4 v94, s[52:55], s16 offen lds
    s_add_u32 m0, s42, 3072
    s_add_u32 s24, s16, 18432
    buffer_load_dwordx4 v94, s[52:55], s24 offen lds
    s_add_u32 s42, s42, s33
    s_add_u32 s27, s27, 1
    s_cmp_eq_u32 s27, 9
    s_cselect_b32 s27, 0, s27
    s_waitcnt vmcnt(8)
    s_barrier
    s_mul_i32 s15, s27, s32
    s_add_u32 s15, s15, s40
    s_add_u32 m0, s42, 0
    s_add_u32 s16, s15, s43
    buffer_load_dwordx4 v94, s[52:55], s15 offen lds
    s_add_u32 m0, s42, 1024
    s_add_u32 s24, s15, 18432
    buffer_load_dwordx4 v94, s[52:55], s24 offen lds
    s_add_u32 m0, s42, 2048
    s_nop 0
    buffer_load_dwordx4 v94, s[52:55], s16 offen lds
    s_add_u32 m0, s42, 3072
    s_add_u32 s24, s16, 18432
    buffer_load_dwordx4 v94, s[52:55], s24 offen lds
    s_add_u32 s42, s42, s33
    s_add_u32 s27, s27, 1
    s_cmp_eq_u32 s27, 9
    s_cselect_b32 s27, 0, s27
    s_waitcnt vmcnt(8)
    s_barrier
    s_waitcnt vmcnt(4)
    s_barrier
    s_waitcnt vmcnt(0)
    s_barrier
    ds_read_b32 v0, v101 offset:8
    s_waitcnt lgkmcnt(0)
    s_branch L_p1_light
L_p1_w4:
    v_bfe_u32 v96, v2, 2, 2
    v_xor_b32 v96, v96, v3
    v_lshlrev_b32 v96, 4, v96
    v_lshl_add_u32 v96, v2, 6, v96
    v_bfe_u32 v97, v1, 2, 2
    v_and_b32 v98, 1, v1
    v_bfe_u32 v99, v1, 1, 1
    v_lshl_or_b32 v98, v98, 1, v99
    v_bfe_u32 v99, v1, 4, 1
    v_lshl_or_b32 v98, v99, 2, v98
    v_lshl_add_u32 v93, v3, 3, v97
    v_lshlrev_b32 v93, 6, v93
    v_lshl_add_u32 v93, v98, 3, v93
    s_lshl_b32 s25, s12, 11
    s_add_u32 s25, s25, 73728
    v_bfe_u32 v108, v2, 1, 2
    v_xor_b32 v108, v108, v3
    v_lshlrev_b32 v108, 4, v108
    v_lshl_add_u32 v105, v2, 6, v108
    v_add_u32 v105, s25, v105
    v_add_u32 v106, s25, v4
    v_lshrrev_b32 v108, 2, v1
    v_bfe_u32 v109, v1, 3, 2
    v_xor_b32 v109, v109, v1
    v_and_b32 v109, 3, v109
    v_mul_u32_u24 v107, 1152, v108
    v_lshl_add_u32 v107, v109, 4, v107
    v_xor_b32 v108, 32, v105
    v_add_u32 v91, s46, v96
    v_xor_b32 v92, 32, v91
    v_add_u32 v93, 73728, v93
    s_lshl_b32 s23, s36, 1
    s_add_u32 s23, s23, s38
    s_mul_i32 s21, s23, 36864
    s_lshl_b32 s22, s26, 6
    s_add_u32 s21, s21, s22
    s_add_u32 s21, s21, 1024
    s_lshl_b32 s29, s23, 5
    s_and_b32 s22, s26, 1
    s_lshl_b32 s22, s22, 4
    s_add_u32 s29, s29, s22
    s_add_u32 s29, s29, 11612160
    s_cmp_eq_u32 s26, 3
    s_cbranch_scc1 L_p1_v
    s_barrier
    ds_read_b64_tr_b16 v[8:9], v93 offset:0
    ds_read_b64_tr_b16 v[10:11], v93 offset:256
    ds_read_b128 v[12:15], v91 offset:0
    ds_read_b64_tr_b16 v[16:17], v93 offset:1024
    ds_read_b64_tr_b16 v[18:19], v93 offset:1280
    ds_read_b128 v[20:23], v92 offset:0
    ds_read_b64_tr_b16 v[24:25], v93 offset:2048
    ds_read_b64_tr_b16 v[26:27], v93 offset:2304
    ds_read_b128 v[28:31], v91 offset:2048
    ds_read_b64_tr_b16 v[32:33], v93 offset:3072
    ds_read_b64_tr_b16 v[34:35], v93 offset:3328
    ds_read_b128 v[36:39], v92 offset:2048
    s_waitcnt lgkmcnt(0)
    ds_read_b64_tr_b16 v[40:41], v93 offset:4096
    ds_read_b64_tr_b16 v[42:43], v93 offset:4352
    ds_read_b128 v[44:47], v91 offset:4096
    v_mfma_f32_32x32x16_bf16 v[72:87], v[8:11], v[12:15], 0
    ds_read_b64_tr_b16 v[48:49], v93 offset:5120
    ds_read_b64_tr_b16 v[50:51], v93 offset:5376
    ds_read_b128 v[52:55], v92 offset:4096
    v_mfma_f32_32x32x16_bf16 v[72:87], v[16:19], v[20:23], v[72:87]
    ds_read_b64_tr_b16 v[56:57], v93 offset:6144
    ds_read_b64_tr_b16 v[58:59], v93 offset:6400
    ds_read_b128 v[60:63], v91 offset:6144
    v_mfma_f32_32x32x16_bf16 v[72:87], v[24:27], v[28:31], v[72:87]
    ds_read_b64_tr_b16 v[64:65], v93 offset:7168
    ds_read_b64_tr_b16 v[66:67], v93 offset:7424
    ds_read_b128 v[68:71], v92 offset:6144
    v_mfma_f32_32x32x16_bf16 v[72:87], v[32:35], v[36:39], v[72:87]
    s_waitcnt lgkmcnt(0)
    ds_read_b64_tr_b16 v[8:9], v93 offset:8192
    ds_read_b64_tr_b16 v[10:11], v93 offset:8448
    ds_read_b128 v[12:15], v91 offset:8192
    v_mfma_f32_32x32x16_bf16 v[72:87], v[40:43], v[44:47], v[72:87]
    ds_read_b64_tr_b16 v[16:17], v93 offset:9216
    ds_read_b64_tr_b16 v[18:19], v93 offset:9472
    ds_read_b128 v[20:23], v92 offset:8192
    v_mfma_f32_32x32x16_bf16 v[72:87], v[48:51], v[52:55], v[72:87]
    ds_read_b64_tr_b16 v[24:25], v93 offset:10240
    ds_read_b64_tr_b16 v[26:27], v93 offset:10496
    ds_read_b128 v[28:31], v91 offset:10240
    v_mfma_f32_32x32x16_bf16 v[72:87], v[56:59], v[60:63], v[72:87]
    ds_read_b64_tr_b16 v[32:33], v93 offset:11264
    ds_read_b64_tr_b16 v[34:35], v93 offset:11520
    ds_read_b128 v[36:39], v92 offset:10240
    v_mfma_f32_32x32x16_bf16 v[72:87], v[64:67], v[68:71], v[72:87]
    s_waitcnt lgkmcnt(0)
    s_barrier
    ds_read_b64_tr_b16 v[40:41], v93 offset:12288
    ds_read_b64_tr_b16 v[42:43], v93 offset:12544
    ds_read_b128 v[44:47], v91 offset:12288
    v_mfma_f32_32x32x16_bf16 v[72:87], v[8:11], v[12:15], v[72:87]
    ds_read_b64_tr_b16 v[48:49], v93 offset:13312
    ds_read_b64_tr_b16 v[50:51], v93 offset:13568
    ds_read_b128 v[52:55], v92 offset:12288
    v_mfma_f32_32x32x16_bf16 v[72:87], v[16:19], v[20:23], v[72:87]
    ds_read_b64_tr_b16 v[56:57], v93 offset:14336
    ds_read_b64_tr_b16 v[58:59], v93 offset:14592
    ds_read_b128 v[60:63], v91 offset:14336
    v_mfma_f32_32x32x16_bf16 v[72:87], v[24:27], v[28:31], v[72:87]
    ds_read_b64_tr_b16 v[64:65], v93 offset:15360
    ds_read_b64_tr_b16 v[66:67], v93 offset:15616
    ds_read_b128 v[68:71], v92 offset:14336
    v_mfma_f32_32x32x16_bf16 v[72:87], v[32:35], v[36:39], v[72:87]
    s_waitcnt lgkmcnt(0)
    ds_read_b64_tr_b16 v[8:9], v93 offset:16384
    ds_read_b64_tr_b16 v[10:11], v93 offset:16640
    ds_read_b128 v[12:15], v91 offset:16384
    v_mfma_f32_32x32x16_bf16 v[72:87], v[40:43], v[44:47], v[72:87]
    ds_read_b64_tr_b16 v[16:17], v93 offset:17408
    ds_read_b64_tr_b16 v[18:19], v93 offset:17664
    ds_read_b128 v[20:23], v92 offset:16384
    v_mfma_f32_32x32x16_bf16 v[72:87], v[48:51], v[52:55], v[72:87]
    ds_read_b64_tr_b16 v[24:25], v93 offset:18432
    ds_read_b64_tr_b16 v[26:27], v93 offset:18688
    ds_read_b128 v[28:31], v91 offset:18432
    v_mfma_f32_32x32x16_bf16 v[72:87], v[56:59], v[60:63], v[72:87]
    ds_read_b64_tr_b16 v[32:33], v93 offset:19456
    ds_read_b64_tr_b16 v[34:35], v93 offset:19712
    ds_read_b128 v[36:39], v92 offset:18432
    v_mfma_f32_32x32x16_bf16 v[72:87], v[64:67], v[68:71], v[72:87]
    s_waitcnt lgkmcnt(0)
    ds_read_b64_tr_b16 v[40:41], v93 offset:20480
    ds_read_b64_tr_b16 v[42:43], v93 offset:20736
    ds_read_b128 v[44:47], v91 offset:20480
    v_mfma_f32_32x32x16_bf16 v[72:87], v[8:11], v[12:15], v[72:87]
    ds_read_b64_tr_b16 v[48:49], v93 offset:21504
    ds_read_b64_tr_b16 v[50:51], v93 offset:21760
    ds_read_b128 v[52:55], v92 offset:20480
    v_mfma_f32_32x32x16_bf16 v[72:87], v[16:19], v[20:23], v[72:87]
    ds_read_b64_tr_b16 v[56:57], v93 offset:22528
    ds_read_b64_tr_b16 v[58:59], v93 offset:22784
    ds_read_b128 v[60:63], v91 offset:22528
    v_mfma_f32_32x32x16_bf16 v[72:87], v[24:27], v[28:31], v[72:87]
    ds_read_b64_tr_b16 v[64:65], v93 offset:23552
    ds_read_b64_tr_b16 v[66:67], v93 offset:23808
    ds_read_b128 v[68:71], v92 offset:22528
    v_mfma_f32_32x32x16_bf16 v[72:87], v[32:35], v[36:39], v[72:87]
    s_waitcnt lgkmcnt(0)
    s_barrier
    ds_read_b64_tr_b16 v[8:9], v93 offset:24576
    ds_read_b64_tr_b16 v[10:11], v93 offset:24832
    ds_read_b128 v[12:15], v91 offset:24576
    v_mfma_f32_32x32x16_bf16 v[72:87], v[40:43], v[44:47], v[72:87]
    ds_read_b64_tr_b16 v[16:17], v93 offset:25600
    ds_read_b64_tr_b16 v[18:19], v93 offset:25856
    ds_read_b128 v[20:23], v92 offset:24576
    v_mfma_f32_32x32x16_bf16 v[72:87], v[48:51], v[52:55], v[72:87]
    ds_read_b64_tr_b16 v[24:25], v93 offset:26624
    ds_read_b64_tr_b16 v[26:27], v93 offset:26880
    ds_read_b128 v[28:31], v91 offset:26624
    v_mfma_f32_32x32x16_bf16 v[72:87], v[56:59], v[60:63], v[72:87]
    ds_read_b64_tr_b16 v[32:33], v93 offset:27648
    ds_read_b64_tr_b16 v[34:35], v93 offset:27904
    ds_read_b128 v[36:39], v92 offset:26624
    v_mfma_f32_32x32x16_bf16 v[72:87], v[64:67], v[68:71], v[72:87]
    s_waitcnt lgkmcnt(0)
    ds_read_b64_tr_b16 v[40:41], v93 offset:28672
    ds_read_b64_tr_b16 v[42:43], v93 offset:28928
    ds_read_b128 v[44:47], v91 offset:28672
    v_mfma_f32_32x32x16_bf16 v[72:87], v[8:11], v[12:15], v[72:87]
    ds_read_b64_tr_b16 v[48:49], v93 offset:29696
    ds_read_b64_tr_b16 v[50:51], v93 offset:29952
    ds_read_b128 v[52:55], v92 offset:28672
    v_mfma_f32_32x32x16_bf16 v[72:87], v[16:19], v[20:23], v[72:87]
    ds_read_b64_tr_b16 v[56:57], v93 offset:30720
    ds_read_b64_tr_b16 v[58:59], v93 offset:30976
    ds_read_b128 v[60:63], v91 offset:30720
    v_mfma_f32_32x32x16_bf16 v[72:87], v[24:27], v[28:31], v[72:87]
    ds_read_b64_tr_b16 v[64:65], v93 offset:31744
    ds_read_b64_tr_b16 v[66:67], v93 offset:32000
    ds_read_b128 v[68:71], v92 offset:30720
    v_mfma_f32_32x32x16_bf16 v[72:87], v[32:35], v[36:39], v[72:87]
    s_waitcnt lgkmcnt(0)
    ds_read_b64_tr_b16 v[8:9], v93 offset:32768
    ds_read_b64_tr_b16 v[10:11], v93 offset:33024
    ds_read_b128 v[12:15], v91 offset:32768
    v_mfma_f32_32x32x16_bf16 v[72:87], v[40:43], v[44:47], v[72:87]
    ds_read_b64_tr_b16 v[16:17], v93 offset:33792
    ds_read_b64_tr_b16 v[18:19], v93 offset:34048
    ds_read_b128 v[20:23], v92 offset:32768
    v_mfma_f32_32x32x16_bf16 v[72:87], v[48:51], v[52:55], v[72:87]
    ds_read_b64_tr_b16 v[24:25], v93 offset:34816
    ds_read_b64_tr_b16 v[26:27], v93 offset:35072
    ds_read_b128 v[28:31], v91 offset:34816
    v_mfma_f32_32x32x16_bf16 v[72:87], v[56:59], v[60:63], v[72:87]
    ds_read_b64_tr_b16 v[32:33], v93 offset:35840
    ds_read_b64_tr_b16 v[34:35], v93 offset:36096
    ds_read_b128 v[36:39], v92 offset:34816
    v_mfma_f32_32x32x16_bf16 v[72:87], v[64:67], v[68:71], v[72:87]
    s_waitcnt lgkmcnt(0)
    v_mfma_f32_32x32x16_bf16 v[72:87], v[8:11], v[12:15], v[72:87]
    v_mfma_f32_32x32x16_bf16 v[72:87], v[16:19], v[20:23], v[72:87]
    v_mfma_f32_32x32x16_bf16 v[72:87], v[24:27], v[28:31], v[72:87]
    v_mfma_f32_32x32x16_bf16 v[72:87], v[32:35], v[36:39], v[72:87]
    ds_read_b32 v0, v101 offset:8
    s_cmp_lt_u32 s26, 2
    s_cbranch_scc1 L_p1_xq
    s_lshl_b32 s22, s23, 10
    s_add_u32 s22, s22, 2359296
    s_lshl_b32 s23, s23, 7
    s_add_u32 s23, s23, 2424832
    v_lshlrev_b32 v88, 2, v2
    v_lshl_add_u32 v88, v3, 30, v88
    s_nop 4
    v_cvt_pk_bf16_f32 v8, v72, v73
    v_cvt_pk_bf16_f32 v9, v74, v75
    v_cvt_pk_bf16_f32 v10, v76, v77
    v_cvt_pk_bf16_f32 v11, v78, v79
    v_cvt_pk_bf16_f32 v12, v80, v81
    buffer_store_dwordx4 v[8:11], v4, s[8:11], s22 offen sc1
    buffer_store_dword v12, v88, s[8:11], s23 offen sc1
    s_branch L_p1_kvf
L_p1_v:
    s_barrier
    ds_read_b64_tr_b16 v[8:9], v93 offset:0
    ds_read_b64_tr_b16 v[10:11], v93 offset:256
    ds_read_b128 v[12:15], v91 offset:0
    ds_read_b64_tr_b16 v[16:17], v93 offset:1024
    ds_read_b64_tr_b16 v[18:19], v93 offset:1280
    ds_read_b128 v[20:23], v92 offset:0
    ds_read_b64_tr_b16 v[24:25], v93 offset:2048
    ds_read_b64_tr_b16 v[26:27], v93 offset:2304
    ds_read_b128 v[28:31], v91 offset:2048
    ds_read_b64_tr_b16 v[32:33], v93 offset:3072
    ds_read_b64_tr_b16 v[34:35], v93 offset:3328
    ds_read_b128 v[36:39], v92 offset:2048
    s_waitcnt lgkmcnt(0)
    ds_read_b64_tr_b16 v[40:41], v93 offset:4096
    ds_read_b64_tr_b16 v[42:43], v93 offset:4352
    ds_read_b128 v[44:47], v91 offset:4096
    v_mfma_f32_32x32x16_bf16 v[72:87], v[12:15], v[8:11], 0
    ds_read_b64_tr_b16 v[48:49], v93 offset:5120
    ds_read_b64_tr_b16 v[50:51], v93 offset:5376
    ds_read_b128 v[52:55], v92 offset:4096
    v_mfma_f32_32x32x16_bf16 v[72:87], v[20:23], v[16:19], v[72:87]
    ds_read_b64_tr_b16 v[56:57], v93 offset:6144
    ds_read_b64_tr_b16 v[58:59], v93 offset:6400
    ds_read_b128 v[60:63], v91 offset:6144
    v_mfma_f32_32x32x16_bf16 v[72:87], v[28:31], v[24:27], v[72:87]
    ds_read_b64_tr_b16 v[64:65], v93 offset:7168
    ds_read_b64_tr_b16 v[66:67], v93 offset:7424
    ds_read_b128 v[68:71], v92 offset:6144
    v_mfma_f32_32x32x16_bf16 v[72:87], v[36:39], v[32:35], v[72:87]
    s_waitcnt lgkmcnt(0)
    ds_read_b64_tr_b16 v[8:9], v93 offset:8192
    ds_read_b64_tr_b16 v[10:11], v93 offset:8448
    ds_read_b128 v[12:15], v91 offset:8192
    v_mfma_f32_32x32x16_bf16 v[72:87], v[44:47], v[40:43], v[72:87]
    ds_read_b64_tr_b16 v[16:17], v93 offset:9216
    ds_read_b64_tr_b16 v[18:19], v93 offset:9472
    ds_read_b128 v[20:23], v92 offset:8192
    v_mfma_f32_32x32x16_bf16 v[72:87], v[52:55], v[48:51], v[72:87]
    ds_read_b64_tr_b16 v[24:25], v93 offset:10240
    ds_read_b64_tr_b16 v[26:27], v93 offset:10496
    ds_read_b128 v[28:31], v91 offset:10240
    v_mfma_f32_32x32x16_bf16 v[72:87], v[60:63], v[56:59], v[72:87]
    ds_read_b64_tr_b16 v[32:33], v93 offset:11264
    ds_read_b64_tr_b16 v[34:35], v93 offset:11520
    ds_read_b128 v[36:39], v92 offset:10240
    v_mfma_f32_32x32x16_bf16 v[72:87], v[68:71], v[64:67], v[72:87]
    s_waitcnt lgkmcnt(0)
    s_barrier
    ds_read_b64_tr_b16 v[40:41], v93 offset:12288
    ds_read_b64_tr_b16 v[42:43], v93 offset:12544
    ds_read_b128 v[44:47], v91 offset:12288
    v_mfma_f32_32x32x16_bf16 v[72:87], v[12:15], v[8:11], v[72:87]
    ds_read_b64_tr_b16 v[48:49], v93 offset:13312
    ds_read_b64_tr_b16 v[50:51], v93 offset:13568
    ds_read_b128 v[52:55], v92 offset:12288
    v_mfma_f32_32x32x16_bf16 v[72:87], v[20:23], v[16:19], v[72:87]
    ds_read_b64_tr_b16 v[56:57], v93 offset:14336
    ds_read_b64_tr_b16 v[58:59], v93 offset:14592
    ds_read_b128 v[60:63], v91 offset:14336
    v_mfma_f32_32x32x16_bf16 v[72:87], v[28:31], v[24:27], v[72:87]
    ds_read_b64_tr_b16 v[64:65], v93 offset:15360
    ds_read_b64_tr_b16 v[66:67], v93 offset:15616
    ds_read_b128 v[68:71], v92 offset:14336
    v_mfma_f32_32x32x16_bf16 v[72:87], v[36:39], v[32:35], v[72:87]
    s_waitcnt lgkmcnt(0)
    ds_read_b64_tr_b16 v[8:9], v93 offset:16384
    ds_read_b64_tr_b16 v[10:11], v93 offset:16640
    ds_read_b128 v[12:15], v91 offset:16384
    v_mfma_f32_32x32x16_bf16 v[72:87], v[44:47], v[40:43], v[72:87]
    ds_read_b64_tr_b16 v[16:17], v93 offset:17408
    ds_read_b64_tr_b16 v[18:19], v93 offset:17664
    ds_read_b128 v[20:23], v92 offset:16384
    v_mfma_f32_32x32x16_bf16 v[72:87], v[52:55], v[48:51], v[72:87]
    ds_read_b64_tr_b16 v[24:25], v93 offset:18432
    ds_read_b64_tr_b16 v[26:27], v93 offset:18688
    ds_read_b128 v[28:31], v91 offset:18432
    v_mfma_f32_32x32x16_bf16 v[72:87], v[60:63], v[56:59], v[72:87]
    ds_read_b64_tr_b16 v[32:33], v93 offset:19456
    ds_read_b64_tr_b16 v[34:35], v93 offset:19712
    ds_read_b128 v[36:39], v92 offset:18432
    v_mfma_f32_32x32x16_bf16 v[72:87], v[68:71], v[64:67], v[72:87]
    s_waitcnt lgkmcnt(0)
    ds_read_b64_tr_b16 v[40:41], v93 offset:20480
    ds_read_b64_tr_b16 v[42:43], v93 offset:20736
    ds_read_b128 v[44:47], v91 offset:20480
    v_mfma_f32_32x32x16_bf16 v[72:87], v[12:15], v[8:11], v[72:87]
    ds_read_b64_tr_b16 v[48:49], v93 offset:21504
    ds_read_b64_tr_b16 v[50:51], v93 offset:21760
    ds_read_b128 v[52:55], v92 offset:20480
    v_mfma_f32_32x32x16_bf16 v[72:87], v[20:23], v[16:19], v[72:87]
    ds_read_b64_tr_b16 v[56:57], v93 offset:22528
    ds_read_b64_tr_b16 v[58:59], v93 offset:22784
    ds_read_b128 v[60:63], v91 offset:22528
    v_mfma_f32_32x32x16_bf16 v[72:87], v[28:31], v[24:27], v[72:87]
    ds_read_b64_tr_b16 v[64:65], v93 offset:23552
    ds_read_b64_tr_b16 v[66:67], v93 offset:23808
    ds_read_b128 v[68:71], v92 offset:22528
    v_mfma_f32_32x32x16_bf16 v[72:87], v[36:39], v[32:35], v[72:87]
    s_waitcnt lgkmcnt(0)
    s_barrier
    ds_read_b64_tr_b16 v[8:9], v93 offset:24576
    ds_read_b64_tr_b16 v[10:11], v93 offset:24832
    ds_read_b128 v[12:15], v91 offset:24576
    v_mfma_f32_32x32x16_bf16 v[72:87], v[44:47], v[40:43], v[72:87]
    ds_read_b64_tr_b16 v[16:17], v93 offset:25600
    ds_read_b64_tr_b16 v[18:19], v93 offset:25856
    ds_read_b128 v[20:23], v92 offset:24576
    v_mfma_f32_32x32x16_bf16 v[72:87], v[52:55], v[48:51], v[72:87]
    ds_read_b64_tr_b16 v[24:25], v93 offset:26624
    ds_read_b64_tr_b16 v[26:27], v93 offset:26880
    ds_read_b128 v[28:31], v91 offset:26624
    v_mfma_f32_32x32x16_bf16 v[72:87], v[60:63], v[56:59], v[72:87]
    ds_read_b64_tr_b16 v[32:33], v93 offset:27648
    ds_read_b64_tr_b16 v[34:35], v93 offset:27904
    ds_read_b128 v[36:39], v92 offset:26624
    v_mfma_f32_32x32x16_bf16 v[72:87], v[68:71], v[64:67], v[72:87]
    s_waitcnt lgkmcnt(0)
    ds_read_b64_tr_b16 v[40:41], v93 offset:28672
    ds_read_b64_tr_b16 v[42:43], v93 offset:28928
    ds_read_b128 v[44:47], v91 offset:28672
    v_mfma_f32_32x32x16_bf16 v[72:87], v[12:15], v[8:11], v[72:87]
    ds_read_b64_tr_b16 v[48:49], v93 offset:29696
    ds_read_b64_tr_b16 v[50:51], v93 offset:29952
    ds_read_b128 v[52:55], v92 offset:28672
    v_mfma_f32_32x32x16_bf16 v[72:87], v[20:23], v[16:19], v[72:87]
    ds_read_b64_tr_b16 v[56:57], v93 offset:30720
    ds_read_b64_tr_b16 v[58:59], v93 offset:30976
    ds_read_b128 v[60:63], v91 offset:30720
    v_mfma_f32_32x32x16_bf16 v[72:87], v[28:31], v[24:27], v[72:87]
    ds_read_b64_tr_b16 v[64:65], v93 offset:31744
    ds_read_b64_tr_b16 v[66:67], v93 offset:32000
    ds_read_b128 v[68:71], v92 offset:30720
    v_mfma_f32_32x32x16_bf16 v[72:87], v[36:39], v[32:35], v[72:87]
    s_waitcnt lgkmcnt(0)
    ds_read_b64_tr_b16 v[8:9], v93 offset:32768
    ds_read_b64_tr_b16 v[10:11], v93 offset:33024
    ds_read_b128 v[12:15], v91 offset:32768
    v_mfma_f32_32x32x16_bf16 v[72:87], v[44:47], v[40:43], v[72:87]
    ds_read_b64_tr_b16 v[16:17], v93 offset:33792
    ds_read_b64_tr_b16 v[18:19], v93 offset:34048
    ds_read_b128 v[20:23], v92 offset:32768
    v_mfma_f32_32x32x16_bf16 v[72:87], v[52:55], v[48:51], v[72:87]
    ds_read_b64_tr_b16 v[24:25], v93 offset:34816
    ds_read_b64_tr_b16 v[26:27], v93 offset:35072
    ds_read_b128 v[28:31], v91 offset:34816
    v_mfma_f32_32x32x16_bf16 v[72:87], v[60:63], v[56:59], v[72:87]
    ds_read_b64_tr_b16 v[32:33], v93 offset:35840
    ds_read_b64_tr_b16 v[34:35], v93 offset:36096
    ds_read_b128 v[36:39], v92 offset:34816
    v_mfma_f32_32x32x16_bf16 v[72:87], v[68:71], v[64:67], v[72:87]
    s_waitcnt lgkmcnt(0)
    v_mfma_f32_32x32x16_bf16 v[72:87], v[12:15], v[8:11], v[72:87]
    v_mfma_f32_32x32x16_bf16 v[72:87], v[20:23], v[16:19], v[72:87]
    v_mfma_f32_32x32x16_bf16 v[72:87], v[28:31], v[24:27], v[72:87]
    v_mfma_f32_32x32x16_bf16 v[72:87], v[36:39], v[32:35], v[72:87]
    ds_read_b32 v0, v101 offset:8
    s_mov_b32 s20, 0x53800000
    v_cmp_eq_u32 vcc, 18, v2
    v_cmp_gt_u32 s[30:31], 19, v2
    v_mov_b32 v89, 0x53805380
    v_mul_u32_u24 v88, 304, v3
    v_lshl_add_u32 v88, v2, 4, v88
    v_mov_b32 v90, 1073741824
    s_mul_i32 s23, s23, 1216
    s_add_u32 s23, s23, 2433024
    v_cndmask_b32 v88, v90, v88, s[30:31]
    s_nop 2
    v_mul_f32 v72, s20, v72
    v_mul_f32 v73, s20, v73
    v_mul_f32 v74, s20, v74
    v_mul_f32 v75, s20, v75
    v_mul_f32 v76, s20, v76
    v_mul_f32 v77, s20, v77
    v_mul_f32 v78, s20, v78
    v_mul_f32 v79, s20, v79
    v_mul_f32 v80, s20, v80
    v_mul_f32 v81, s20, v81
    v_mul_f32 v82, s20, v82
    v_mul_f32 v83, s20, v83
    v_mul_f32 v84, s20, v84
    v_mul_f32 v85, s20, v85
    v_mul_f32 v86, s20, v86
    v_mul_f32 v87, s20, v87
    v_cvt_pk_bf16_f32 v8, v72, v73
    v_cvt_pk_bf16_f32 v9, v74, v75
    v_cvt_pk_bf16_f32 v10, v76, v77
    v_cvt_pk_bf16_f32 v11, v78, v79
    v_cvt_pk_bf16_f32 v12, v80, v81
    v_cvt_pk_bf16_f32 v13, v82, v83
    v_cvt_pk_bf16_f32 v14, v84, v85
    v_cvt_pk_bf16_f32 v15, v86, v87
    v_cndmask_b32 v8, v8, v89, vcc
    v_cndmask_b32 v9, v9, v89, vcc
    v_cndmask_b32 v10, v10, v89, vcc
    v_cndmask_b32 v11, v11, v89, vcc
    v_cndmask_b32 v12, v12, v89, vcc
    v_cndmask_b32 v13, v13, v89, vcc
    v_cndmask_b32 v14, v14, v89, vcc
    v_cndmask_b32 v15, v15, v89, vcc
    buffer_store_dwordx4 v[8:11], v88, s[8:11], s23 offen sc1
    buffer_store_dwordx4 v[12:15], v88, s[8:11], s23 offen offset:608 sc1
L_p1_kvf:
    s_barrier
    s_barrier
    s_barrier
    s_waitcnt vmcnt(0) lgkmcnt(0)
    s_mov_b64 exec, 1
    buffer_store_dword v0, v223, s[8:11], s29 offen sc1
    s_mov_b64 exec, -1
    s_barrier
    s_barrier
    s_barrier
    s_barrier
    s_barrier
    s_barrier
    s_branch L_p1_end
L_p1_xq:
    s_barrier
    s_barrier
    s_barrier
    s_barrier
    s_barrier
    s_barrier
    s_barrier
    s_barrier
    s_barrier
    s_branch L_p1_qs0
L_p1_main:
    s_mov_b32 s24, 11632640
    buffer_load_dword v0, v223, s[8:11], s24 offen sc1
    v_bfe_u32 v96, v2, 2, 2
    v_xor_b32 v96, v96, v3
    v_lshlrev_b32 v96, 4, v96
    v_lshl_add_u32 v96, v2, 6, v96
    v_bfe_u32 v97, v1, 2, 2
    v_and_b32 v98, 1, v1
    v_bfe_u32 v99, v1, 1, 1
    v_lshl_or_b32 v98, v98, 1, v99
    v_bfe_u32 v99, v1, 4, 1
    v_lshl_or_b32 v98, v99, 2, v98
    v_lshl_add_u32 v93, v3, 3, v97
    v_lshlrev_b32 v93, 6, v93
    v_lshl_add_u32 v93, v98, 3, v93
    s_lshl_b32 s25, s12, 11
    s_add_u32 s25, s25, 73728
    v_bfe_u32 v108, v2, 1, 2
    v_xor_b32 v108, v108, v3
    v_lshlrev_b32 v108, 4, v108
    v_lshl_add_u32 v105, v2, 6, v108
    v_add_u32 v105, s25, v105
    v_add_u32 v106, s25, v4
    v_lshrrev_b32 v108, 2, v1
    v_bfe_u32 v109, v1, 3, 2
    v_xor_b32 v109, v109, v1
    v_and_b32 v109, 3, v109
    v_mul_u32_u24 v107, 1152, v108
    v_lshl_add_u32 v107, v109, 4, v107
    v_xor_b32 v108, 32, v105
    s_and_b32 s38, s12, 1
    s_lshr_b32 s39, s12, 1
    s_mul_i32 s24, s38, 36864
    v_add_u32 v91, s24, v96
    v_xor_b32 v92, 32, v91
    s_lshl_b32 s24, s39, 12
    s_add_u32 s24, s24, 110592
    v_add_u32 v93, s24, v93
    s_lshl_b32 s21, s36, 1
    s_add_u32 s21, s21, s38
    s_mul_i32 s21, s21, 36864
    s_lshl_b32 s22, s37, 7
    s_add_u32 s21, s21, s22
    s_lshl_b32 s22, s39, 6
    s_add_u32 s21, s21, s22
    s_barrier
    s_waitcnt vmcnt(0)
    s_mov_b32 s24, 0x9e3779b1
    v_mul_lo_u32 v0, v0, s24
    v_add_u32 v0, 0x7f4a7c15, v0
    ds_write_b32 v101, v0 offset:8
    s_waitcnt lgkmcnt(0)
    s_barrier
    s_barrier
    s_barrier
    ds_read_b64_tr_b16 v[8:9], v93 offset:0
    ds_read_b64_tr_b16 v[10:11], v93 offset:256
    ds_read_b128 v[12:15], v91 offset:0
    ds_read_b64_tr_b16 v[16:17], v93 offset:1024
    ds_read_b64_tr_b16 v[18:19], v93 offset:1280
    ds_read_b128 v[20:23], v92 offset:0
    ds_read_b64_tr_b16 v[24:25], v93 offset:2048
    ds_read_b64_tr_b16 v[26:27], v93 offset:2304
    ds_read_b128 v[28:31], v91 offset:2048
    ds_read_b64_tr_b16 v[32:33], v93 offset:3072
    ds_read_b64_tr_b16 v[34:35], v93 offset:3328
    ds_read_b128 v[36:39], v92 offset:2048
    s_waitcnt lgkmcnt(0)
    s_barrier
    ds_read_b64_tr_b16 v[40:41], v93 offset:8192
    ds_read_b64_tr_b16 v[42:43], v93 offset:8448
    ds_read_b128 v[44:47], v91 offset:4096
    v_mfma_f32_32x32x16_bf16 v[72:87], v[8:11], v[12:15], 0
    ds_read_b64_tr_b16 v[48:49], v93 offset:9216
    ds_read_b64_tr_b16 v[50:51], v93 offset:9472
    ds_read_b128 v[52:55], v92 offset:4096
    v_mfma_f32_32x32x16_bf16 v[72:87], v[16:19], v[20:23], v[72:87]
    ds_read_b64_tr_b16 v[56:57], v93 offset:10240
    ds_read_b64_tr_b16 v[58:59], v93 offset:10496
    ds_read_b128 v[60:63], v91 offset:6144
    v_mfma_f32_32x32x16_bf16 v[72:87], v[24:27], v[28:31], v[72:87]
    ds_read_b64_tr_b16 v[64:65], v93 offset:11264
    ds_read_b64_tr_b16 v[66:67], v93 offset:11520
    ds_read_b128 v[68:71], v92 offset:6144
    v_mfma_f32_32x32x16_bf16 v[72:87], v[32:35], v[36:39], v[72:87]
    s_waitcnt lgkmcnt(0)
    s_barrier
    ds_read_b64_tr_b16 v[8:9], v93 offset:16384
    ds_read_b64_tr_b16 v[10:11], v93 offset:16640
    ds_read_b128 v[12:15], v91 offset:8192
    v_mfma_f32_32x32x16_bf16 v[72:87], v[40:43], v[44:47], v[72:87]
    ds_read_b64_tr_b16 v[16:17], v93 offset:17408
    ds_read_b64_tr_b16 v[18:19], v93 offset:17664
    ds_read_b128 v[20:23], v92 offset:8192
    v_mfma_f32_32x32x16_bf16 v[72:87], v[48:51], v[52:55], v[72:87]
    ds_read_b64_tr_b16 v[24:25], v93 offset:18432
    ds_read_b64_tr_b16 v[26:27], v93 offset:18688
    ds_read_b128 v[28:31], v91 offset:10240
    v_mfma_f32_32x32x16_bf16 v[72:87], v[56:59], v[60:63], v[72:87]
    ds_read_b64_tr_b16 v[32:33], v93 offset:19456
    ds_read_b64_tr_b16 v[34:35], v93 offset:19712
    ds_read_b128 v[36:39], v92 offset:10240
    v_mfma_f32_32x32x16_bf16 v[72:87], v[64:67], v[68:71], v[72:87]
    s_waitcnt lgkmcnt(0)
    s_barrier
    ds_read_b64_tr_b16 v[40:41], v93 offset:24576
    ds_read_b64_tr_b16 v[42:43], v93 offset:24832
    ds_read_b128 v[44:47], v91 offset:12288
    v_mfma_f32_32x32x16_bf16 v[72:87], v[8:11], v[12:15], v[72:87]
    ds_read_b64_tr_b16 v[48:49], v93 offset:25600
    ds_read_b64_tr_b16 v[50:51], v93 offset:25856
    ds_read_b128 v[52:55], v92 offset:12288
    v_mfma_f32_32x32x16_bf16 v[72:87], v[16:19], v[20:23], v[72:87]
    ds_read_b64_tr_b16 v[56:57], v93 offset:26624
    ds_read_b64_tr_b16 v[58:59], v93 offset:26880
    ds_read_b128 v[60:63], v91 offset:14336
    v_mfma_f32_32x32x16_bf16 v[72:87], v[24:27], v[28:31], v[72:87]
    ds_read_b64_tr_b16 v[64:65], v93 offset:27648
    ds_read_b64_tr_b16 v[66:67], v93 offset:27904
    ds_read_b128 v[68:71], v92 offset:14336
    v_mfma_f32_32x32x16_bf16 v[72:87], v[32:35], v[36:39], v[72:87]
    s_waitcnt lgkmcnt(0)
    s_barrier
    ds_read_b64_tr_b16 v[8:9], v93 offset:32768
    ds_read_b64_tr_b16 v[10:11], v93 offset:33024
    ds_read_b128 v[12:15], v91 offset:16384
    v_mfma_f32_32x32x16_bf16 v[72:87], v[40:43], v[44:47], v[72:87]
    ds_read_b64_tr_b16 v[16:17], v93 offset:33792
    ds_read_b64_tr_b16 v[18:19], v93 offset:34048
    ds_read_b128 v[20:23], v92 offset:16384
    v_mfma_f32_32x32x16_bf16 v[72:87], v[48:51], v[52:55], v[72:87]
    ds_read_b64_tr_b16 v[24:25], v93 offset:34816
    ds_read_b64_tr_b16 v[26:27], v93 offset:35072
    ds_read_b128 v[28:31], v91 offset:18432
    v_mfma_f32_32x32x16_bf16 v[72:87], v[56:59], v[60:63], v[72:87]
    ds_read_b64_tr_b16 v[32:33], v93 offset:35840
    ds_read_b64_tr_b16 v[34:35], v93 offset:36096
    ds_read_b128 v[36:39], v92 offset:18432
    v_mfma_f32_32x32x16_bf16 v[72:87], v[64:67], v[68:71], v[72:87]
    s_waitcnt lgkmcnt(0)
    s_barrier
    ds_read_b64_tr_b16 v[40:41], v93 offset:40960
    ds_read_b64_tr_b16 v[42:43], v93 offset:41216
    ds_read_b128 v[44:47], v91 offset:20480
    v_mfma_f32_32x32x16_bf16 v[72:87], v[8:11], v[12:15], v[72:87]
    ds_read_b64_tr_b16 v[48:49], v93 offset:41984
    ds_read_b64_tr_b16 v[50:51], v93 offset:42240
    ds_read_b128 v[52:55], v92 offset:20480
    v_mfma_f32_32x32x16_bf16 v[72:87], v[16:19], v[20:23], v[72:87]
    ds_read_b64_tr_b16 v[56:57], v93 offset:43008
    ds_read_b64_tr_b16 v[58:59], v93 offset:43264
    ds_read_b128 v[60:63], v91 offset:22528
    v_mfma_f32_32x32x16_bf16 v[72:87], v[24:27], v[28:31], v[72:87]
    ds_read_b64_tr_b16 v[64:65], v93 offset:44032
    ds_read_b64_tr_b16 v[66:67], v93 offset:44288
    ds_read_b128 v[68:71], v92 offset:22528
    v_mfma_f32_32x32x16_bf16 v[72:87], v[32:35], v[36:39], v[72:87]
    s_waitcnt lgkmcnt(0)
    s_barrier
    ds_read_b64_tr_b16 v[8:9], v93 offset:0
    ds_read_b64_tr_b16 v[10:11], v93 offset:256
    ds_read_b128 v[12:15], v91 offset:24576
    v_mfma_f32_32x32x16_bf16 v[72:87], v[40:43], v[44:47], v[72:87]
    ds_read_b64_tr_b16 v[16:17], v93 offset:1024
    ds_read_b64_tr_b16 v[18:19], v93 offset:1280
    ds_read_b128 v[20:23], v92 offset:24576
    v_mfma_f32_32x32x16_bf16 v[72:87], v[48:51], v[52:55], v[72:87]
    ds_read_b64_tr_b16 v[24:25], v93 offset:2048
    ds_read_b64_tr_b16 v[26:27], v93 offset:2304
    ds_read_b128 v[28:31], v91 offset:26624
    v_mfma_f32_32x32x16_bf16 v[72:87], v[56:59], v[60:63], v[72:87]
    ds_read_b64_tr_b16 v[32:33], v93 offset:3072
    ds_read_b64_tr_b16 v[34:35], v93 offset:3328
    ds_read_b128 v[36:39], v92 offset:26624
    v_mfma_f32_32x32x16_bf16 v[72:87], v[64:67], v[68:71], v[72:87]
    s_waitcnt lgkmcnt(0)
    s_barrier
    ds_read_b64_tr_b16 v[40:41], v93 offset:8192
    ds_read_b64_tr_b16 v[42:43], v93 offset:8448
    ds_read_b128 v[44:47], v91 offset:28672
    v_mfma_f32_32x32x16_bf16 v[72:87], v[8:11], v[12:15], v[72:87]
    ds_read_b64_tr_b16 v[48:49], v93 offset:9216
    ds_read_b64_tr_b16 v[50:51], v93 offset:9472
    ds_read_b128 v[52:55], v92 offset:28672
    v_mfma_f32_32x32x16_bf16 v[72:87], v[16:19], v[20:23], v[72:87]
    ds_read_b64_tr_b16 v[56:57], v93 offset:10240
    ds_read_b64_tr_b16 v[58:59], v93 offset:10496
    ds_read_b128 v[60:63], v91 offset:30720
    v_mfma_f32_32x32x16_bf16 v[72:87], v[24:27], v[28:31], v[72:87]
    ds_read_b64_tr_b16 v[64:65], v93 offset:11264
    ds_read_b64_tr_b16 v[66:67], v93 offset:11520
    ds_read_b128 v[68:71], v92 offset:30720
    v_mfma_f32_32x32x16_bf16 v[72:87], v[32:35], v[36:39], v[72:87]
    s_waitcnt lgkmcnt(0)
    s_barrier
    ds_read_b64_tr_b16 v[8:9], v93 offset:16384
    ds_read_b64_tr_b16 v[10:11], v93 offset:16640
    ds_read_b128 v[12:15], v91 offset:32768
    v_mfma_f32_32x32x16_bf16 v[72:87], v[40:43], v[44:47], v[72:87]
    ds_read_b64_tr_b16 v[16:17], v93 offset:17408
    ds_read_b64_tr_b16 v[18:19], v93 offset:17664
    ds_read_b128 v[20:23], v92 offset:32768
    v_mfma_f32_32x32x16_bf16 v[72:87], v[48:51], v[52:55], v[72:87]
    ds_read_b64_tr_b16 v[24:25], v93 offset:18432
    ds_read_b64_tr_b16 v[26:27], v93 offset:18688
    ds_read_b128 v[28:31], v91 offset:34816
    v_mfma_f32_32x32x16_bf16 v[72:87], v[56:59], v[60:63], v[72:87]
    ds_read_b64_tr_b16 v[32:33], v93 offset:19456
    ds_read_b64_tr_b16 v[34:35], v93 offset:19712
    ds_read_b128 v[36:39], v92 offset:34816
    v_mfma_f32_32x32x16_bf16 v[72:87], v[64:67], v[68:71], v[72:87]
    s_waitcnt lgkmcnt(0)
    v_mfma_f32_32x32x16_bf16 v[72:87], v[8:11], v[12:15], v[72:87]
    v_mfma_f32_32x32x16_bf16 v[72:87], v[16:19], v[20:23], v[72:87]
    v_mfma_f32_32x32x16_bf16 v[72:87], v[24:27], v[28:31], v[72:87]
    v_mfma_f32_32x32x16_bf16 v[72:87], v[32:35], v[36:39], v[72:87]
L_p1_qs0:
    s_mov_b32 s20, 0x3eae1a93
    s_add_u32 s22, s21, 18432
    s_cmp_lt_u32 s26, 2
    s_cselect_b32 s23, 4, 3
    s_lshl_b32 s29, s36, 7
    s_lshl_b32 s24, s37, 4
    s_add_u32 s29, s29, s24
    s_add_u32 s29, s29, 11608064
    v_mov_b32 v88, 1
    s_nop 2
    v_mul_f32 v72, s20, v72
    v_mul_f32 v73, s20, v73
    v_mul_f32 v74, s20, v74
    v_mul_f32 v75, s20, v75
    v_mul_f32 v76, s20, v76
    v_mul_f32 v77, s20, v77
    v_mul_f32 v78, s20, v78
    v_mul_f32 v79, s20, v79
    v_mul_f32 v80, s20, v80
    v_mul_f32 v81, s20, v81
    v_mul_f32 v82, s20, v82
    v_mul_f32 v83, s20, v83
    v_mul_f32 v84, s20, v84
    v_mul_f32 v85, s20, v85
    v_mul_f32 v86, s20, v86
    v_mul_f32 v87, s20, v87
    v_cvt_pk_bf16_f32 v8, v72, v73
    v_cvt_pk_bf16_f32 v9, v74, v75
    v_cvt_pk_bf16_f32 v10, v76, v77
    v_cvt_pk_bf16_f32 v11, v78, v79
    v_cvt_pk_bf16_f32 v12, v80, v81
    v_cvt_pk_bf16_f32 v13, v82, v83
    v_cvt_pk_bf16_f32 v14, v84, v85
    v_cvt_pk_bf16_f32 v15, v86, v87
    ds_write_b128 v105, v[8:11]
    ds_write_b128 v108, v[12:15]
    ds_read_b128 v[16:19], v106
    ds_read_b128 v[20:23], v106 offset:1024
    s_waitcnt lgkmcnt(1)
    buffer_store_dwordx4 v[16:19], v107, s[8:11], s21 offen sc1
    s_waitcnt lgkmcnt(0)
    buffer_store_dwordx4 v[20:23], v107, s[8:11], s22 offen sc1
    s_waitcnt vmcnt(0)
    s_mov_b64 exec, 1
    ds_add_rtn_u32 v89, v101, v88 offset:12
    s_waitcnt lgkmcnt(0)
    v_readfirstlane_b32 s24, v89
    s_cmp_lg_u32 s24, s23
    s_cbranch_scc1 L_p1_nf
    buffer_store_dword v0, v223, s[8:11], s29 offen sc1
L_p1_nf:
    s_mov_b64 exec, -1
    s_branch L_p1_end
L_p1_light:
    s_cmp_eq_u32 s39, 0
    s_cbranch_scc1 L_p1_end
    s_cmp_lt_u32 s26, 2
    s_cselect_b32 s25, 5, 4
L_lw:
    ds_read_b32 v88, v101 offset:12
    s_waitcnt lgkmcnt(0)
    v_readfirstlane_b32 s24, v88
    s_cmp_ge_u32 s24, s25
    s_cbranch_scc1 L_lw_x
    s_sleep 1
    s_branch L_lw
L_lw_x:
    s_cmp_eq_u32 s39, 0
    s_cbranch_scc1 L_li_x
    s_cmp_eq_u32 s39, 2
    s_cbranch_scc1 L_li_h
    s_movk_i32 s24, 576
    s_add_u32 m0, s28, 0
    s_nop 0
    buffer_load_dwordx4 v120, s[56:59], 0 offen lds
    s_add_u32 m0, s28, 1024
    s_nop 0
    buffer_load_dwordx4 v120, s[56:59], s24 offen lds
    s_add_u32 m0, s28, 2048
    s_nop 0
    buffer_load_dwordx4 v121, s[56:59], 0 offen lds
    s_add_u32 m0, s28, 3072
    s_nop 0
    buffer_load_dwordx4 v121, s[56:59], s24 offen lds
    s_add_u32 m0, s28, 4096
    s_nop 0
    buffer_load_dwordx4 v122, s[56:59], 0 offen lds
    s_add_u32 m0, s28, 5120
    s_nop 0
    buffer_load_dwordx4 v122, s[56:59], s24 offen lds
    s_add_u32 m0, s28, 6144
    s_nop 0
    buffer_load_dwordx4 v123, s[56:59], 0 offen lds
    s_add_u32 m0, s28, 7168
    s_nop 0
    buffer_load_dwordx4 v123, s[56:59], s24 offen lds
    s_branch L_li_x
L_li_h:
    s_add_u32 m0, s28, 0
    s_nop 0
    buffer_load_dwordx4 v120, s[56:59], s21 offen offset:0 lds
    s_add_u32 m0, s28, 1024
    s_nop 0
    buffer_load_dwordx4 v120, s[56:59], s22 offen offset:0 lds
    s_add_u32 m0, s28, 1984
    s_nop 0
    buffer_load_dwordx4 v120, s[56:59], s21 offen offset:64 lds
    s_add_u32 m0, s28, 3008
    s_nop 0
    buffer_load_dwordx4 v120, s[56:59], s22 offen offset:64 lds
    s_add_u32 m0, s28, 3968
    s_nop 0
    buffer_load_dwordx4 v120, s[56:59], s21 offen offset:128 lds
    s_add_u32 m0, s28, 4992
    s_nop 0
    buffer_load_dwordx4 v120, s[56:59], s22 offen offset:128 lds
L_li_x:
    s_waitcnt vmcnt(0)
    s_cmp_eq_u32 s39, 2
    s_cbranch_scc1 L_p1_hid
    ds_read_b128 v[8:11], v124 offset:0
    ds_read_b128 v[12:15], v124 offset:1024
    ds_read_b128 v[16:19], v124 offset:2048
    ds_read_b128 v[20:23], v124 offset:3072
    ds_read_b128 v[24:27], v124 offset:4096
    ds_read_b128 v[28:31], v124 offset:5120
    ds_read_b128 v[32:35], v124 offset:6144
    ds_read_b128 v[36:39], v124 offset:7168
    s_waitcnt lgkmcnt(0)
    v_lshlrev_b32 v40, 16, v8
    v_lshlrev_b32 v41, 16, v12
    v_lshlrev_b32 v42, 16, v16
    v_lshlrev_b32 v43, 16, v20
    v_lshlrev_b32 v44, 16, v24
    v_lshlrev_b32 v45, 16, v28
    v_lshlrev_b32 v46, 16, v32
    v_lshlrev_b32 v47, 16, v36
    v_add_f32 v48, v40, v41
    v_sub_f32 v49, v40, v41
    v_add_f32 v50, v42, v43
    v_sub_f32 v51, v42, v43
    v_add_f32 v52, v44, v45
    v_sub_f32 v53, v44, v45
    v_add_f32 v54, v46, v47
    v_sub_f32 v55, v46, v47
    v_add_f32 v40, v48, v50
    v_sub_f32 v41, v48, v50
    v_add_f32 v42, v52, v54
    v_sub_f32 v43, v52, v54
    v_add_f32 v72, v40, v42
    v_sub_f32 v73, v40, v42
    v_sub_f32 v74, v41, v43
    v_add_f32 v75, v41, v43
    v_add_f32 v44, v49, v51
    v_sub_f32 v45, v49, v51
    v_add_f32 v46, v53, v55
    v_sub_f32 v47, v53, v55
    v_add_f32 v76, v44, v46
    v_sub_f32 v77, v44, v46
    v_sub_f32 v78, v45, v47
    v_add_f32 v79, v45, v47
    v_and_b32 v56, 0xffff0000, v8
    v_and_b32 v57, 0xffff0000, v12
    v_and_b32 v58, 0xffff0000, v16
    v_and_b32 v59, 0xffff0000, v20
    v_and_b32 v60, 0xffff0000, v24
    v_and_b32 v61, 0xffff0000, v28
    v_and_b32 v62, 0xffff0000, v32
    v_and_b32 v63, 0xffff0000, v36
    v_add_f32 v64, v56, v57
    v_sub_f32 v65, v56, v57
    v_add_f32 v66, v58, v59
    v_sub_f32 v67, v58, v59
    v_add_f32 v68, v60, v61
    v_sub_f32 v69, v60, v61
    v_add_f32 v70, v62, v63
    v_sub_f32 v71, v62, v63
    v_add_f32 v56, v64, v66
    v_sub_f32 v57, v64, v66
    v_add_f32 v58, v68, v70
    v_sub_f32 v59, v68, v70
    v_add_f32 v80, v56, v58
    v_sub_f32 v81, v56, v58
    v_sub_f32 v82, v57, v59
    v_add_f32 v83, v57, v59
    v_add_f32 v60, v65, v67
    v_sub_f32 v61, v65, v67
    v_add_f32 v62, v69, v71
    v_sub_f32 v63, v69, v71
    v_add_f32 v84, v60, v62
    v_sub_f32 v85, v60, v62
    v_sub_f32 v86, v61, v63
    v_add_f32 v87, v61, v63
    v_cvt_pk_bf16_f32 v88, v72, v80
    v_cvt_pk_bf16_f32 v92, v76, v84
    v_cvt_pk_bf16_f32 v96, v73, v81
    v_cvt_pk_bf16_f32 v100, v77, v85
    v_cvt_pk_bf16_f32 v104, v74, v82
    v_cvt_pk_bf16_f32 v108, v78, v86
    v_cvt_pk_bf16_f32 v112, v75, v83
    v_cvt_pk_bf16_f32 v116, v79, v87
    v_lshlrev_b32 v40, 16, v9
    v_lshlrev_b32 v41, 16, v13
    v_lshlrev_b32 v42, 16, v17
    v_lshlrev_b32 v43, 16, v21
    v_lshlrev_b32 v44, 16, v25
    v_lshlrev_b32 v45, 16, v29
    v_lshlrev_b32 v46, 16, v33
    v_lshlrev_b32 v47, 16, v37
    v_add_f32 v48, v40, v41
    v_sub_f32 v49, v40, v41
    v_add_f32 v50, v42, v43
    v_sub_f32 v51, v42, v43
    v_add_f32 v52, v44, v45
    v_sub_f32 v53, v44, v45
    v_add_f32 v54, v46, v47
    v_sub_f32 v55, v46, v47
    v_add_f32 v40, v48, v50
    v_sub_f32 v41, v48, v50
    v_add_f32 v42, v52, v54
    v_sub_f32 v43, v52, v54
    v_add_f32 v72, v40, v42
    v_sub_f32 v73, v40, v42
    v_sub_f32 v74, v41, v43
    v_add_f32 v75, v41, v43
    v_add_f32 v44, v49, v51
    v_sub_f32 v45, v49, v51
    v_add_f32 v46, v53, v55
    v_sub_f32 v47, v53, v55
    v_add_f32 v76, v44, v46
    v_sub_f32 v77, v44, v46
    v_sub_f32 v78, v45, v47
    v_add_f32 v79, v45, v47
    v_and_b32 v56, 0xffff0000, v9
    v_and_b32 v57, 0xffff0000, v13
    v_and_b32 v58, 0xffff0000, v17
    v_and_b32 v59, 0xffff0000, v21
    v_and_b32 v60, 0xffff0000, v25
    v_and_b32 v61, 0xffff0000, v29
    v_and_b32 v62, 0xffff0000, v33
    v_and_b32 v63, 0xffff0000, v37
    v_add_f32 v64, v56, v57
    v_sub_f32 v65, v56, v57
    v_add_f32 v66, v58, v59
    v_sub_f32 v67, v58, v59
    v_add_f32 v68, v60, v61
    v_sub_f32 v69, v60, v61
    v_add_f32 v70, v62, v63
    v_sub_f32 v71, v62, v63
    v_add_f32 v56, v64, v66
    v_sub_f32 v57, v64, v66
    v_add_f32 v58, v68, v70
    v_sub_f32 v59, v68, v70
    v_add_f32 v80, v56, v58
    v_sub_f32 v81, v56, v58
    v_sub_f32 v82, v57, v59
    v_add_f32 v83, v57, v59
    v_add_f32 v60, v65, v67
    v_sub_f32 v61, v65, v67
    v_add_f32 v62, v69, v71
    v_sub_f32 v63, v69, v71
    v_add_f32 v84, v60, v62
    v_sub_f32 v85, v60, v62
    v_sub_f32 v86, v61, v63
    v_add_f32 v87, v61, v63
    v_cvt_pk_bf16_f32 v89, v72, v80
    v_cvt_pk_bf16_f32 v93, v76, v84
    v_cvt_pk_bf16_f32 v97, v73, v81
    v_cvt_pk_bf16_f32 v101, v77, v85
    v_cvt_pk_bf16_f32 v105, v74, v82
    v_cvt_pk_bf16_f32 v109, v78, v86
    v_cvt_pk_bf16_f32 v113, v75, v83
    v_cvt_pk_bf16_f32 v117, v79, v87
    v_lshlrev_b32 v40, 16, v10
    v_lshlrev_b32 v41, 16, v14
    v_lshlrev_b32 v42, 16, v18
    v_lshlrev_b32 v43, 16, v22
    v_lshlrev_b32 v44, 16, v26
    v_lshlrev_b32 v45, 16, v30
    v_lshlrev_b32 v46, 16, v34
    v_lshlrev_b32 v47, 16, v38
    v_add_f32 v48, v40, v41
    v_sub_f32 v49, v40, v41
    v_add_f32 v50, v42, v43
    v_sub_f32 v51, v42, v43
    v_add_f32 v52, v44, v45
    v_sub_f32 v53, v44, v45
    v_add_f32 v54, v46, v47
    v_sub_f32 v55, v46, v47
    v_add_f32 v40, v48, v50
    v_sub_f32 v41, v48, v50
    v_add_f32 v42, v52, v54
    v_sub_f32 v43, v52, v54
    v_add_f32 v72, v40, v42
    v_sub_f32 v73, v40, v42
    v_sub_f32 v74, v41, v43
    v_add_f32 v75, v41, v43
    v_add_f32 v44, v49, v51
    v_sub_f32 v45, v49, v51
    v_add_f32 v46, v53, v55
    v_sub_f32 v47, v53, v55
    v_add_f32 v76, v44, v46
    v_sub_f32 v77, v44, v46
    v_sub_f32 v78, v45, v47
    v_add_f32 v79, v45, v47
    v_and_b32 v56, 0xffff0000, v10
    v_and_b32 v57, 0xffff0000, v14
    v_and_b32 v58, 0xffff0000, v18
    v_and_b32 v59, 0xffff0000, v22
    v_and_b32 v60, 0xffff0000, v26
    v_and_b32 v61, 0xffff0000, v30
    v_and_b32 v62, 0xffff0000, v34
    v_and_b32 v63, 0xffff0000, v38
    v_add_f32 v64, v56, v57
    v_sub_f32 v65, v56, v57
    v_add_f32 v66, v58, v59
    v_sub_f32 v67, v58, v59
    v_add_f32 v68, v60, v61
    v_sub_f32 v69, v60, v61
    v_add_f32 v70, v62, v63
    v_sub_f32 v71, v62, v63
    v_add_f32 v56, v64, v66
    v_sub_f32 v57, v64, v66
    v_add_f32 v58, v68, v70
    v_sub_f32 v59, v68, v70
    v_add_f32 v80, v56, v58
    v_sub_f32 v81, v56, v58
    v_sub_f32 v82, v57, v59
    v_add_f32 v83, v57, v59
    v_add_f32 v60, v65, v67
    v_sub_f32 v61, v65, v67
    v_add_f32 v62, v69, v71
    v_sub_f32 v63, v69, v71
    v_add_f32 v84, v60, v62
    v_sub_f32 v85, v60, v62
    v_sub_f32 v86, v61, v63
    v_add_f32 v87, v61, v63
    v_cvt_pk_bf16_f32 v90, v72, v80
    v_cvt_pk_bf16_f32 v94, v76, v84
    v_cvt_pk_bf16_f32 v98, v73, v81
    v_cvt_pk_bf16_f32 v102, v77, v85
    v_cvt_pk_bf16_f32 v106, v74, v82
    v_cvt_pk_bf16_f32 v110, v78, v86
    v_cvt_pk_bf16_f32 v114, v75, v83
    v_cvt_pk_bf16_f32 v118, v79, v87
    v_lshlrev_b32 v40, 16, v11
    v_lshlrev_b32 v41, 16, v15
    v_lshlrev_b32 v42, 16, v19
    v_lshlrev_b32 v43, 16, v23
    v_lshlrev_b32 v44, 16, v27
    v_lshlrev_b32 v45, 16, v31
    v_lshlrev_b32 v46, 16, v35
    v_lshlrev_b32 v47, 16, v39
    v_add_f32 v48, v40, v41
    v_sub_f32 v49, v40, v41
    v_add_f32 v50, v42, v43
    v_sub_f32 v51, v42, v43
    v_add_f32 v52, v44, v45
    v_sub_f32 v53, v44, v45
    v_add_f32 v54, v46, v47
    v_sub_f32 v55, v46, v47
    v_add_f32 v40, v48, v50
    v_sub_f32 v41, v48, v50
    v_add_f32 v42, v52, v54
    v_sub_f32 v43, v52, v54
    v_add_f32 v72, v40, v42
    v_sub_f32 v73, v40, v42
    v_sub_f32 v74, v41, v43
    v_add_f32 v75, v41, v43
    v_add_f32 v44, v49, v51
    v_sub_f32 v45, v49, v51
    v_add_f32 v46, v53, v55
    v_sub_f32 v47, v53, v55
    v_add_f32 v76, v44, v46
    v_sub_f32 v77, v44, v46
    v_sub_f32 v78, v45, v47
    v_add_f32 v79, v45, v47
    v_and_b32 v56, 0xffff0000, v11
    v_and_b32 v57, 0xffff0000, v15
    v_and_b32 v58, 0xffff0000, v19
    v_and_b32 v59, 0xffff0000, v23
    v_and_b32 v60, 0xffff0000, v27
    v_and_b32 v61, 0xffff0000, v31
    v_and_b32 v62, 0xffff0000, v35
    v_and_b32 v63, 0xffff0000, v39
    v_add_f32 v64, v56, v57
    v_sub_f32 v65, v56, v57
    v_add_f32 v66, v58, v59
    v_sub_f32 v67, v58, v59
    v_add_f32 v68, v60, v61
    v_sub_f32 v69, v60, v61
    v_add_f32 v70, v62, v63
    v_sub_f32 v71, v62, v63
    v_add_f32 v56, v64, v66
    v_sub_f32 v57, v64, v66
    v_add_f32 v58, v68, v70
    v_sub_f32 v59, v68, v70
    v_add_f32 v80, v56, v58
    v_sub_f32 v81, v56, v58
    v_sub_f32 v82, v57, v59
    v_add_f32 v83, v57, v59
    v_add_f32 v60, v65, v67
    v_sub_f32 v61, v65, v67
    v_add_f32 v62, v69, v71
    v_sub_f32 v63, v69, v71
    v_add_f32 v84, v60, v62
    v_sub_f32 v85, v60, v62
    v_sub_f32 v86, v61, v63
    v_add_f32 v87, v61, v63
    v_cvt_pk_bf16_f32 v91, v72, v80
    v_cvt_pk_bf16_f32 v95, v76, v84
    v_cvt_pk_bf16_f32 v99, v73, v81
    v_cvt_pk_bf16_f32 v103, v77, v85
    v_cvt_pk_bf16_f32 v107, v74, v82
    v_cvt_pk_bf16_f32 v111, v78, v86
    v_cvt_pk_bf16_f32 v115, v75, v83
    v_cvt_pk_bf16_f32 v119, v79, v87
    s_add_u32 s20, s29, 4980736
    buffer_store_dwordx4 v[88:91], v125, s[8:11], s20 offen sc1
    s_add_u32 s20, s29, 5312512
    buffer_store_dwordx4 v[92:95], v125, s[8:11], s20 offen sc1
    s_add_u32 s20, s29, 5644288
    buffer_store_dwordx4 v[96:99], v125, s[8:11], s20 offen sc1
    s_add_u32 s20, s29, 5976064
    buffer_store_dwordx4 v[100:103], v125, s[8:11], s20 offen sc1
    s_add_u32 s20, s29, 6307840
    buffer_store_dwordx4 v[104:107], v125, s[8:11], s20 offen sc1
    s_add_u32 s20, s29, 6639616
    buffer_store_dwordx4 v[108:111], v125, s[8:11], s20 offen sc1
    s_add_u32 s20, s29, 6971392
    buffer_store_dwordx4 v[112:115], v125, s[8:11], s20 offen sc1
    s_add_u32 s20, s29, 7303168
    buffer_store_dwordx4 v[116:119], v125, s[8:11], s20 offen sc1
    s_branch L_p1_end
L_p1_hid:
    ds_read_b128 v[88:91], v124 offset:0
    ds_read_b128 v[92:95], v124 offset:32
    ds_read_b128 v[96:99], v124 offset:2048
    ds_read_b128 v[100:103], v124 offset:2080
    ds_read_b128 v[104:107], v124 offset:4096
    ds_read_b128 v[108:111], v124 offset:4128
    s_add_u32 s20, s29, 4096
    s_waitcnt lgkmcnt(0)
    buffer_store_dwordx4 v[88:91], v4, s[8:11], s29 offen offset:0 sc1
    buffer_store_dwordx4 v[92:95], v4, s[8:11], s29 offen offset:1024 sc1
    buffer_store_dwordx4 v[96:99], v4, s[8:11], s29 offen offset:2048 sc1
    buffer_store_dwordx4 v[100:103], v4, s[8:11], s29 offen offset:3072 sc1
    buffer_store_dwordx4 v[104:107], v4, s[8:11], s20 offen offset:0 sc1
    buffer_store_dwordx4 v[108:111], v4, s[8:11], s20 offen offset:1024 sc1
L_p1_end:
    s_lshl_b32 s35, s2, 4
    s_add_u32 s35, s35, 11599872
    s_mov_b32 s58, s76
    s_mov_b32 s59, s77
    v_mul_u32_u24 v200, 36, v2
    v_lshl_add_u32 v201, v3, 4, v200
    v_lshl_add_u32 v202, v3, 30, v200
    v_mul_u32_u24 v203, 304, v3
    v_add_u32 v206, 288, v203
    v_lshl_add_u32 v203, v2, 4, v203
    v_mov_b32 v204, 1073741824
    v_cmp_gt_u32 vcc, 18, v2
    v_cmp_eq_u32 s[30:31], 20, v2
    v_lshlrev_b32 v205, 2, v2
    v_mov_b32 v40, 0x3f803f80
    v_mov_b32 v41, 0x3f803f80
    v_mov_b32 v42, 0x3f803f80
    v_mov_b32 v43, 0x3f803f80
    v_mov_b32 v44, 0x3f803f80
    v_mov_b32 v45, 0x3f803f80
    v_mov_b32 v46, 0x3f803f80
    v_mov_b32 v47, 0x3f803f80
    v_cndmask_b32 v203, v204, v203, vcc
    v_cndmask_b32 v218, v203, v206, s[30:31]
    v_mov_b32 v173, 0
    v_mov_b32 v174, 0
    s_lshl_b32 s25, s12, 11
    v_add_u32 v6, s25, v4
    s_add_u32 s14, s13, s12
    s_mul_i32 s14, s14, 1152
    s_lshr_b32 s24, s2, 3
    s_add_u32 s25, s24, s12
    s_and_b32 s25, s25, 7
    s_lshl_b32 s25, s25, 2
    s_lshr_b32 s24, s24, 3
    s_add_u32 s28, s24, 0
    s_and_b32 s28, s28, 3
    s_add_u32 s28, s28, s25
    s_lshl_b32 s71, s28, 11
    s_add_u32 s71, s71, 2359296
    s_lshl_b32 s75, s28, 8
    s_add_u32 s75, s75, 2424832
    s_mul_i32 s79, s28, 2432
    s_add_u32 s79, s79, 2433024
    s_add_u32 s28, s24, 1
    s_and_b32 s28, s28, 3
    s_add_u32 s28, s28, s25
    s_lshl_b32 s72, s28, 11
    s_add_u32 s72, s72, 2359296
    s_lshl_b32 s76, s28, 8
    s_add_u32 s76, s76, 2424832
    s_mul_i32 s100, s28, 2432
    s_add_u32 s100, s100, 2433024
    s_add_u32 s28, s24, 2
    s_and_b32 s28, s28, 3
    s_add_u32 s28, s28, s25
    s_lshl_b32 s73, s28, 11
    s_add_u32 s73, s73, 2359296
    s_lshl_b32 s77, s28, 8
    s_add_u32 s77, s77, 2424832
    s_mul_i32 s101, s28, 2432
    s_add_u32 s101, s101, 2433024
    s_add_u32 s28, s24, 3
    s_and_b32 s28, s28, 3
    s_add_u32 s28, s28, s25
    s_lshl_b32 s74, s28, 11
    s_add_u32 s74, s74, 2359296
    s_lshl_b32 s78, s28, 8
    s_add_u32 s78, s78, 2424832
    s_mul_i32 s3, s28, 2432
    s_add_u32 s3, s3, 2433024
    s_mov_b32 s52, 0
    s_cmp_eq_u32 s12, 5
    s_cbranch_scc1 L_sj_pf
    s_cmp_gt_u32 s12, 3
    s_cbranch_scc1 L_sj_done
    s_mov_b32 s52, 4
    s_cmp_eq_u32 s12, 3
    s_cbranch_scc1 L_sj_seq
    s_cmp_ge_u32 s2, 240
    s_cbranch_scc1 L_sj_done
    s_mul_i32 s17, s2, 3
    s_add_u32 s17, s17, s12
    s_mul_hi_u32 s15, s17, 858993460
    s_mul_i32 s16, s15, 5
    s_sub_u32 s16, s17, s16
    s_mul_i32 s53, s15, 18432
    s_add_u32 s53, s53, 4980736
    s_mul_hi_u32 s18, s15, 477218589
    s_mul_i32 s19, s18, 9
    s_sub_u32 s19, s15, s19
    s_bfe_u32 s26, s18, 0x10001
    s_lshr_b32 s54, s18, 3
    s_lshl_b32 s54, s54, 1
    s_add_u32 s54, s54, s26
    s_mul_i32 s54, s54, 5
    s_add_u32 s54, s54, s16
    s_mul_i32 s54, s54, 18432
    s_add_u32 s54, s54, 9895936
    s_lshr_b32 s55, s18, 2
    s_lshl_b32 s55, s55, 1
    s_and_b32 s15, s18, 1
    s_add_u32 s55, s55, s15
    s_mul_i32 s55, s55, 9
    s_add_u32 s55, s55, s19
    s_mul_i32 s55, s55, 20480
    s_mul_i32 s26, s26, 2560
    s_add_u32 s55, s55, s26
    s_lshl_b32 s16, s16, 9
    s_add_u32 s55, s55, s16
    s_add_u32 s55, s55, 7667712
    v_mul_u32_u24 v219, 5120, v3
    v_lshl_add_u32 v219, v2, 4, v219
    s_mov_b32 s52, 1
    s_branch L_sj_done
L_sj_seq:
    s_cmp_ge_u32 s2, 204
    s_cbranch_scc1 L_sj_done
    s_mul_hi_u32 s17, s2, 715827883
    s_mul_i32 s19, s17, 6
    s_sub_u32 s19, s2, s19
    s_mul_i32 s19, s19, 3
    s_cmp_ge_u32 s17, 17
    s_cselect_b32 s18, 1, 0
    s_mul_i32 s26, s18, 17
    s_sub_u32 s17, s17, s26
    s_cmp_ge_u32 s17, 9
    s_addc_u32 s17, s17, 0
    s_cmp_ge_u32 s17, 10
    s_cselect_b32 s26, 1, 0
    s_mul_i32 s27, s26, 10
    s_sub_u32 s27, s17, s27
    s_lshl_b32 s27, s27, 6
    s_add_u32 s27, s27, s26
    s_lshl_b32 s53, s27, 12
    s_lshl_b32 s26, s19, 6
    s_add_u32 s53, s53, s26
    s_mul_i32 s55, s18, 18
    s_add_u32 s55, s55, s17
    s_mul_i32 s55, s55, 34816
    s_lshl_b32 s26, s19, 10
    s_add_u32 s55, s55, s26
    s_add_u32 s55, s55, 10289152
    s_mov_b32 s54, s19
    v_lshlrev_b32 v219, 13, v2
    v_lshl_add_u32 v219, v3, 5, v219
    s_mov_b32 s52, 2
    s_branch L_sj_done
L_sj_pf:
    s_lshr_b32 s16, s2, 3
    s_mul_i32 s53, s16, 20736
    s_mov_b32 s52, 3
L_sj_done:
    s_mov_b32 s22, 0
    v_mov_b32 v212, 160832
    s_cmp_eq_u32 s18, 1
    s_cselect_b32 s48, s62, s60
    s_cselect_b32 s49, s63, s61
    s_cmp_eq_u32 s52, 3
    s_cselect_b32 s48, s58, s48
    s_cselect_b32 s49, s59, s49
    s_mov_b32 s50, 8388608
    s_cselect_b32 s50, 663552, s50
    s_mov_b32 s51, 0x00020000
    s_bfe_u32 s18, s2, 0x10002
    s_lshr_b32 s15, s2, 3
    s_mul_i32 s16, s18, 3
    s_sub_u32 s16, 27, s16
    s_cmp_lt_u32 s15, s16
    s_cselect_b32 s33, 1, 0
    s_cselect_b32 s15, s15, 0
    s_mul_hi_u32 s16, s15, 1431655766
    s_mul_i32 s17, s16, 3
    s_sub_u32 s17, s15, s17
    s_and_b32 s15, s2, 3
    s_mul_i32 s15, s15, 3
    s_add_u32 s17, s17, s15
    s_mul_i32 s15, s18, 10
    s_add_u32 s16, s16, s15
    s_bfe_u32 s19, s12, 0x10001
    s_and_b32 s26, s12, 1
    s_lshr_b32 s27, s12, 2
    s_lshl_b32 s68, s19, 1
    s_add_u32 s68, s68, s18
    s_lshl_b32 s68, s68, 1
    s_add_u32 s68, s68, s26
    s_mul_i32 s68, s68, 184320
    s_mul_i32 s24, s17, 192
    s_add_u32 s68, s68, s24
    s_mul_i32 s24, s27, 92160
    s_add_u32 s68, s68, s24
    s_add_u32 s68, s68, 7667712
    s_mul_i32 s69, s19, 18
    s_add_u32 s69, s69, s16
    s_lshl_b32 s69, s69, 1
    s_add_u32 s69, s69, s26
    s_mul_i32 s69, s69, 17408
    s_mul_i32 s24, s27, 9216
    s_add_u32 s69, s69, s24
    s_add_u32 s69, s69, 10289152
    s_lshr_b32 s36, s13, 6
    s_bfe_u32 s37, s13, 0x30003
    s_lshl_b32 s38, s36, 7
    s_add_u32 s38, s38, 11603968
    s_lshl_b32 s39, s37, 2
    s_add_u32 s39, s39, s38
    s_mov_b32 s60, s58
    s_mov_b32 s61, s59
    s_mov_b32 s62, 663552
    s_mov_b32 s63, 0x00020000
    s_mov_b32 s64, s6
    s_mov_b32 s65, s7
    s_mov_b32 s66, 4718592
    s_mov_b32 s67, 0x00020000
    s_mul_i32 s45, s12, 17920
    s_add_u32 s45, s45, 16384
    s_lshl_b32 s40, s37, 7
    s_add_u32 s41, s40, 64
    s_bfe_u32 s42, s37, 0x10001
    s_lshl_b32 s42, s42, 6
    s_add_u32 s42, s42, 1024
    s_lshl_b32 s43, s37, 2
    s_add_u32 s43, s43, s12
    s_add_u32 s24, s43, 0
    s_and_b32 s24, s24, 31
    s_mul_i32 s96, s24, 20736
    s_add_u32 s24, s43, 8
    s_and_b32 s24, s24, 31
    s_mul_i32 s97, s24, 20736
    s_add_u32 s24, s43, 16
    s_and_b32 s24, s24, 31
    s_mul_i32 s98, s24, 20736
    s_add_u32 s24, s43, 24
    s_and_b32 s24, s24, 31
    s_mul_i32 s99, s24, 20736
    s_mul_i32 s44, s12, 165888
    s_lshr_b32 s28, s13, 5
    s_mul_i32 s28, s28, 36864
    s_and_b32 s29, s13, 31
    s_lshl_b32 s29, s29, 4
    s_add_u32 s28, s28, s29
    s_add_u32 s28, s28, 2621440
    s_lshl_b32 s29, s12, 12
    s_add_u32 s29, s29, s28
    s_add_u32 s28, s28, 32768
    s_mov_b32 s70, 18432
    s_cmp_lg_u32 s12, 5
    s_cbranch_scc1 L_f1_x
    s_lshr_b32 s25, s13, 6
    s_lshl_b32 s25, s25, 7
    s_add_u32 s25, s25, 11608064
    v_and_b32 v243, 7, v1
    v_lshlrev_b32 v243, 4, v243
    s_mov_b32 s21, 40000
    s_mov_b32 s24, 11612160
L_f1:
    buffer_load_dword v240, v4, s[8:11], s24 offen offset:0 sc1
    buffer_load_dword v241, v4, s[8:11], s24 offen offset:1024 sc1
    s_waitcnt vmcnt(0)
    v_xor_b32 v240, v240, v0
    v_xor_b32 v241, v241, v0
    v_or_b32 v240, v240, v241
    v_cmp_ne_u32 vcc, 0, v240
    s_sub_u32 s21, s21, 1
    s_cbranch_vccz L_f0a
    s_sleep 2
    s_cmp_gt_i32 s21, 0
    s_cbranch_scc1 L_f1
L_f0a:
    v_mov_b32 v241, 1
    ds_write_b32 v212, v241 offset:16
L_f0:
    buffer_load_dword v240, v243, s[8:11], s25 offen sc1
    s_waitcnt vmcnt(0)
    v_cmp_ne_u32 vcc, v0, v240
    s_sub_u32 s21, s21, 1
    s_cbranch_vccz L_f1_ok
    s_sleep 2
    s_cmp_gt_i32 s21, 0
    s_cbranch_scc1 L_f0
L_f1_ok:
    v_mov_b32 v241, 2
    ds_write_b32 v212, v241 offset:16
    s_branch L_go_x
L_f1_x:
    s_cmp_ge_u32 s12, 4
    s_cbranch_scc1 L_go
    s_bfe_u32 s25, s13, 0x10005
    s_sub_u32 s25, 5, s25
L_g1:
    ds_read2_b32 v[240:241], v212 offset0:3 offset1:4
    s_waitcnt lgkmcnt(0)
    v_readfirstlane_b32 s24, v240
    v_readfirstlane_b32 s21, v241
    s_cmp_ge_u32 s24, s25
    s_cselect_b32 s21, s21, 0
    s_cmp_lg_u32 s21, 0
    s_cbranch_scc1 L_g1_x
    s_sleep 1
    s_branch L_g1
L_g1_x:
    buffer_load_dwordx4 v[8:11], v4, s[8:11], s71 offen offset:0 sc1
    buffer_load_dwordx4 v[12:15], v4, s[8:11], s71 offen offset:1024 sc1
    buffer_load_dwordx4 v[16:19], v4, s[8:11], s72 offen offset:0 sc1
    buffer_load_dwordx4 v[20:23], v4, s[8:11], s72 offen offset:1024 sc1
    buffer_load_dwordx4 v[24:27], v4, s[8:11], s73 offen offset:0 sc1
    buffer_load_dwordx4 v[28:31], v4, s[8:11], s73 offen offset:1024 sc1
    buffer_load_dwordx4 v[32:35], v4, s[8:11], s74 offen offset:0 sc1
    buffer_load_dwordx4 v[36:39], v4, s[8:11], s74 offen offset:1024 sc1
    s_mov_b32 exec_hi, 0
    buffer_load_dword v40, v205, s[8:11], s75 offen offset:0 sc1
    buffer_load_dword v41, v205, s[8:11], s75 offen offset:128 sc1
    buffer_load_dword v42, v205, s[8:11], s76 offen offset:0 sc1
    buffer_load_dword v43, v205, s[8:11], s76 offen offset:128 sc1
    buffer_load_dword v44, v205, s[8:11], s77 offen offset:0 sc1
    buffer_load_dword v45, v205, s[8:11], s77 offen offset:128 sc1
    buffer_load_dword v46, v205, s[8:11], s78 offen offset:0 sc1
    buffer_load_dword v47, v205, s[8:11], s78 offen offset:128 sc1
    s_mov_b32 exec_hi, -1
    buffer_load_dwordx4 v[48:51], v218, s[8:11], s79 offen offset:0 sc1
    buffer_load_dwordx4 v[52:55], v218, s[8:11], s79 offen offset:608 sc1
    buffer_load_dwordx4 v[56:59], v218, s[8:11], s79 offen offset:1216 sc1
    buffer_load_dwordx4 v[60:63], v218, s[8:11], s79 offen offset:1824 sc1
    buffer_load_dwordx4 v[64:67], v218, s[8:11], s100 offen offset:0 sc1
    buffer_load_dwordx4 v[68:71], v218, s[8:11], s100 offen offset:608 sc1
    buffer_load_dwordx4 v[72:75], v218, s[8:11], s100 offen offset:1216 sc1
    buffer_load_dwordx4 v[76:79], v218, s[8:11], s100 offen offset:1824 sc1
    buffer_load_dwordx4 v[80:83], v218, s[8:11], s101 offen offset:0 sc1
    buffer_load_dwordx4 v[84:87], v218, s[8:11], s101 offen offset:608 sc1
    buffer_load_dwordx4 v[88:91], v218, s[8:11], s101 offen offset:1216 sc1
    buffer_load_dwordx4 v[92:95], v218, s[8:11], s101 offen offset:1824 sc1
    buffer_load_dwordx4 v[96:99], v218, s[8:11], s3 offen offset:0 sc1
    buffer_load_dwordx4 v[100:103], v218, s[8:11], s3 offen offset:608 sc1
    buffer_load_dwordx4 v[104:107], v218, s[8:11], s3 offen offset:1216 sc1
    buffer_load_dwordx4 v[108:111], v218, s[8:11], s3 offen offset:1824 sc1
L_go:
    ds_read_b32 v241, v212 offset:16
    s_waitcnt lgkmcnt(0)
    v_readfirstlane_b32 s24, v241
    s_cmp_eq_u32 s24, 2
    s_cbranch_scc1 L_go_x
    s_sleep 1
    s_branch L_go
L_go_x:
    buffer_load_dwordx4 v[168:171], v201, s[8:11], s14 offen sc1
    buffer_load_dword v172, v202, s[8:11], s14 offen offset:32 sc1
    s_setprio 3
    s_waitcnt vmcnt(0)
    s_cmp_lt_u32 s12, 4
    s_cbranch_scc1 L_at_w1
    s_sub_u32 s24, 7, s12
    s_cmp_gt_u32 s24, 1
    s_cbranch_scc1 L_at_w0
    v_mov_b32 v215, 1
    v_mov_b32 v214, 160836
    s_mov_b64 exec, 1
    ds_add_rtn_u32 v214, v214, v215
    s_waitcnt lgkmcnt(0)
    v_readfirstlane_b32 s24, v214
    s_cmp_lg_u32 s24, 1
    s_cbranch_scc1 L_jd1
    buffer_store_dword v0, v223, s[8:11], s35 offen offset:4 sc1
L_jd1:
    s_mov_b64 exec, -1
L_at_w0:
    buffer_load_dwordx4 v[8:11], v4, s[8:11], s71 offen offset:0 sc1
    buffer_load_dwordx4 v[12:15], v4, s[8:11], s71 offen offset:1024 sc1
    buffer_load_dwordx4 v[16:19], v4, s[8:11], s72 offen offset:0 sc1
    buffer_load_dwordx4 v[20:23], v4, s[8:11], s72 offen offset:1024 sc1
    buffer_load_dwordx4 v[24:27], v4, s[8:11], s73 offen offset:0 sc1
    buffer_load_dwordx4 v[28:31], v4, s[8:11], s73 offen offset:1024 sc1
    buffer_load_dwordx4 v[32:35], v4, s[8:11], s74 offen offset:0 sc1
    buffer_load_dwordx4 v[36:39], v4, s[8:11], s74 offen offset:1024 sc1
    s_mov_b32 exec_hi, 0
    buffer_load_dword v40, v205, s[8:11], s75 offen offset:0 sc1
    buffer_load_dword v41, v205, s[8:11], s75 offen offset:128 sc1
    buffer_load_dword v42, v205, s[8:11], s76 offen offset:0 sc1
    buffer_load_dword v43, v205, s[8:11], s76 offen offset:128 sc1
    buffer_load_dword v44, v205, s[8:11], s77 offen offset:0 sc1
    buffer_load_dword v45, v205, s[8:11], s77 offen offset:128 sc1
    buffer_load_dword v46, v205, s[8:11], s78 offen offset:0 sc1
    buffer_load_dword v47, v205, s[8:11], s78 offen offset:128 sc1
    s_mov_b32 exec_hi, -1
    buffer_load_dwordx4 v[48:51], v218, s[8:11], s79 offen offset:0 sc1
    buffer_load_dwordx4 v[52:55], v218, s[8:11], s79 offen offset:608 sc1
    buffer_load_dwordx4 v[56:59], v218, s[8:11], s79 offen offset:1216 sc1
    buffer_load_dwordx4 v[60:63], v218, s[8:11], s79 offen offset:1824 sc1
    buffer_load_dwordx4 v[64:67], v218, s[8:11], s100 offen offset:0 sc1
    buffer_load_dwordx4 v[68:71], v218, s[8:11], s100 offen offset:608 sc1
    buffer_load_dwordx4 v[72:75], v218, s[8:11], s100 offen offset:1216 sc1
    buffer_load_dwordx4 v[76:79], v218, s[8:11], s100 offen offset:1824 sc1
    buffer_load_dwordx4 v[80:83], v218, s[8:11], s101 offen offset:0 sc1
    buffer_load_dwordx4 v[84:87], v218, s[8:11], s101 offen offset:608 sc1
    buffer_load_dwordx4 v[88:91], v218, s[8:11], s101 offen offset:1216 sc1
    buffer_load_dwordx4 v[92:95], v218, s[8:11], s101 offen offset:1824 sc1
    buffer_load_dwordx4 v[96:99], v218, s[8:11], s3 offen offset:0 sc1
    buffer_load_dwordx4 v[100:103], v218, s[8:11], s3 offen offset:608 sc1
    buffer_load_dwordx4 v[104:107], v218, s[8:11], s3 offen offset:1216 sc1
    buffer_load_dwordx4 v[108:111], v218, s[8:11], s3 offen offset:1824 sc1
    s_waitcnt vmcnt(0)
L_at_w1:
    v_mfma_f32_32x32x16_bf16 v[112:127], v[8:11], v[168:171], 0
    v_mfma_f32_32x32x8_bf16 v[112:127], v[40:41], v[172:173], v[112:127]
    s_nop 11
    v_max3_f32 v209, v112, v113, v114
    v_max3_f32 v210, v115, v116, v117
    v_max3_f32 v211, v118, v119, v120
    v_max3_f32 v212, v121, v122, v123
    v_max3_f32 v213, v124, v125, v126
    v_max3_f32 v209, v209, v210, v127
    v_max3_f32 v211, v211, v212, v213
    v_max_f32 v214, v209, v211
    v_mov_b32 v215, v214
    s_nop 1
    v_permlane32_swap_b32 v214, v215
    s_nop 1
    v_max_f32 v214, v214, v215
    v_add_f32 v214, 0x42be0000, v214
    v_xor_b32 v214, 0x80000000, v214
    v_lshrrev_b32 v214, 16, v214
    v_mul_u32_u24 v214, v214, v3
    v_or_b32 v172, v172, v214
    v_mov_b32 v175, v172
    ds_write_b128 v6, v[168:171] offset:0
L_at_main:
    v_mfma_f32_32x32x16_bf16 v[112:127], v[8:11], v[168:171], 0
    v_mfma_f32_32x32x8_bf16 v[112:127], v[40:41], v[172:173], v[112:127]
    s_lshl_b32 s24, s12, 2
    s_add_u32 s24, s24, 160800
    v_mov_b32 v221, s24
    s_nop 9
    v_exp_f32 v112, v112
    v_exp_f32 v113, v113
    v_exp_f32 v114, v114
    v_exp_f32 v115, v115
    v_cvt_pk_bf16_f32 v144, v112, v113
    v_cvt_pk_bf16_f32 v145, v114, v115
    v_mfma_f32_32x32x16_bf16 v[128:143], v[12:15], v[168:171], 0
    v_exp_f32 v116, v116
    v_exp_f32 v117, v117
    v_exp_f32 v118, v118
    v_exp_f32 v119, v119
    v_cvt_pk_bf16_f32 v146, v116, v117
    v_cvt_pk_bf16_f32 v147, v118, v119
    v_mfma_f32_32x32x8_bf16 v[128:143], v[40:41], v[174:175], v[128:143]
    v_exp_f32 v120, v120
    v_exp_f32 v121, v121
    v_exp_f32 v122, v122
    v_exp_f32 v123, v123
    v_cvt_pk_bf16_f32 v148, v120, v121
    v_cvt_pk_bf16_f32 v149, v122, v123
    v_mfma_f32_32x32x16_bf16 v[184:199], v[48:51], v[144:147], 0
    v_exp_f32 v124, v124
    v_exp_f32 v125, v125
    v_exp_f32 v126, v126
    v_exp_f32 v127, v127
    v_cvt_pk_bf16_f32 v150, v124, v125
    v_cvt_pk_bf16_f32 v151, v126, v127
    v_exp_f32 v128, v128
    v_exp_f32 v129, v129
    v_mfma_f32_32x32x16_bf16 v[184:199], v[52:55], v[148:151], v[184:199]
    v_exp_f32 v130, v130
    v_exp_f32 v131, v131
    v_cvt_pk_bf16_f32 v144, v128, v129
    v_cvt_pk_bf16_f32 v145, v130, v131
    v_mfma_f32_32x32x16_bf16 v[112:127], v[16:19], v[168:171], 0
    v_exp_f32 v132, v132
    v_exp_f32 v133, v133
    v_exp_f32 v134, v134
    v_exp_f32 v135, v135
    v_cvt_pk_bf16_f32 v146, v132, v133
    v_cvt_pk_bf16_f32 v147, v134, v135
    v_mfma_f32_32x32x8_bf16 v[112:127], v[42:43], v[172:173], v[112:127]
    v_exp_f32 v136, v136
    v_exp_f32 v137, v137
    v_exp_f32 v138, v138
    v_exp_f32 v139, v139
    v_cvt_pk_bf16_f32 v148, v136, v137
    v_cvt_pk_bf16_f32 v149, v138, v139
    v_mfma_f32_32x32x16_bf16 v[184:199], v[56:59], v[144:147], v[184:199]
    v_exp_f32 v140, v140
    v_exp_f32 v141, v141
    v_exp_f32 v142, v142
    v_exp_f32 v143, v143
    v_cvt_pk_bf16_f32 v150, v140, v141
    v_cvt_pk_bf16_f32 v151, v142, v143
    v_exp_f32 v112, v112
    v_exp_f32 v113, v113
    v_mfma_f32_32x32x16_bf16 v[184:199], v[60:63], v[148:151], v[184:199]
    v_exp_f32 v114, v114
    v_exp_f32 v115, v115
    v_cvt_pk_bf16_f32 v144, v112, v113
    v_cvt_pk_bf16_f32 v145, v114, v115
    v_mfma_f32_32x32x16_bf16 v[128:143], v[20:23], v[168:171], 0
    v_exp_f32 v116, v116
    v_exp_f32 v117, v117
    v_exp_f32 v118, v118
    v_exp_f32 v119, v119
    v_cvt_pk_bf16_f32 v146, v116, v117
    v_cvt_pk_bf16_f32 v147, v118, v119
    v_mfma_f32_32x32x8_bf16 v[128:143], v[42:43], v[174:175], v[128:143]
    v_exp_f32 v120, v120
    v_exp_f32 v121, v121
    v_exp_f32 v122, v122
    v_exp_f32 v123, v123
    v_cvt_pk_bf16_f32 v148, v120, v121
    v_cvt_pk_bf16_f32 v149, v122, v123
    v_mfma_f32_32x32x16_bf16 v[184:199], v[64:67], v[144:147], v[184:199]
    v_exp_f32 v124, v124
    v_exp_f32 v125, v125
    v_exp_f32 v126, v126
    v_exp_f32 v127, v127
    v_cvt_pk_bf16_f32 v150, v124, v125
    v_cvt_pk_bf16_f32 v151, v126, v127
    v_exp_f32 v128, v128
    v_exp_f32 v129, v129
    v_mfma_f32_32x32x16_bf16 v[184:199], v[68:71], v[148:151], v[184:199]
    v_exp_f32 v130, v130
    v_exp_f32 v131, v131
    v_cvt_pk_bf16_f32 v144, v128, v129
    v_cvt_pk_bf16_f32 v145, v130, v131
    v_mfma_f32_32x32x16_bf16 v[112:127], v[24:27], v[168:171], 0
    v_exp_f32 v132, v132
    v_exp_f32 v133, v133
    v_exp_f32 v134, v134
    v_exp_f32 v135, v135
    v_cvt_pk_bf16_f32 v146, v132, v133
    v_cvt_pk_bf16_f32 v147, v134, v135
    v_mfma_f32_32x32x8_bf16 v[112:127], v[44:45], v[172:173], v[112:127]
    v_exp_f32 v136, v136
    v_exp_f32 v137, v137
    v_exp_f32 v138, v138
    v_exp_f32 v139, v139
    v_cvt_pk_bf16_f32 v148, v136, v137
    v_cvt_pk_bf16_f32 v149, v138, v139
    v_mfma_f32_32x32x16_bf16 v[184:199], v[72:75], v[144:147], v[184:199]
    v_exp_f32 v140, v140
    v_exp_f32 v141, v141
    v_exp_f32 v142, v142
    v_exp_f32 v143, v143
    v_cvt_pk_bf16_f32 v150, v140, v141
    v_cvt_pk_bf16_f32 v151, v142, v143
    v_exp_f32 v112, v112
    v_exp_f32 v113, v113
    v_mfma_f32_32x32x16_bf16 v[184:199], v[76:79], v[148:151], v[184:199]
    v_exp_f32 v114, v114
    v_exp_f32 v115, v115
    v_cvt_pk_bf16_f32 v144, v112, v113
    v_cvt_pk_bf16_f32 v145, v114, v115
    v_mfma_f32_32x32x16_bf16 v[128:143], v[28:31], v[168:171], 0
    v_exp_f32 v116, v116
    v_exp_f32 v117, v117
    v_exp_f32 v118, v118
    v_exp_f32 v119, v119
    v_cvt_pk_bf16_f32 v146, v116, v117
    v_cvt_pk_bf16_f32 v147, v118, v119
    v_mfma_f32_32x32x8_bf16 v[128:143], v[44:45], v[174:175], v[128:143]
    v_exp_f32 v120, v120
    v_exp_f32 v121, v121
    v_exp_f32 v122, v122
    v_exp_f32 v123, v123
    v_cvt_pk_bf16_f32 v148, v120, v121
    v_cvt_pk_bf16_f32 v149, v122, v123
    v_mfma_f32_32x32x16_bf16 v[184:199], v[80:83], v[144:147], v[184:199]
    v_exp_f32 v124, v124
    v_exp_f32 v125, v125
    v_exp_f32 v126, v126
    v_exp_f32 v127, v127
    v_cvt_pk_bf16_f32 v150, v124, v125
    v_cvt_pk_bf16_f32 v151, v126, v127
    v_exp_f32 v128, v128
    v_exp_f32 v129, v129
    v_mfma_f32_32x32x16_bf16 v[184:199], v[84:87], v[148:151], v[184:199]
    v_exp_f32 v130, v130
    v_exp_f32 v131, v131
    v_cvt_pk_bf16_f32 v144, v128, v129
    v_cvt_pk_bf16_f32 v145, v130, v131
    v_mfma_f32_32x32x16_bf16 v[112:127], v[32:35], v[168:171], 0
    v_exp_f32 v132, v132
    v_exp_f32 v133, v133
    v_exp_f32 v134, v134
    v_exp_f32 v135, v135
    v_cvt_pk_bf16_f32 v146, v132, v133
    v_cvt_pk_bf16_f32 v147, v134, v135
    v_mfma_f32_32x32x8_bf16 v[112:127], v[46:47], v[172:173], v[112:127]
    v_exp_f32 v136, v136
    v_exp_f32 v137, v137
    v_exp_f32 v138, v138
    v_exp_f32 v139, v139
    v_cvt_pk_bf16_f32 v148, v136, v137
    v_cvt_pk_bf16_f32 v149, v138, v139
    v_mfma_f32_32x32x16_bf16 v[184:199], v[88:91], v[144:147], v[184:199]
    v_exp_f32 v140, v140
    v_exp_f32 v141, v141
    v_exp_f32 v142, v142
    v_exp_f32 v143, v143
    v_cvt_pk_bf16_f32 v150, v140, v141
    v_cvt_pk_bf16_f32 v151, v142, v143
    v_exp_f32 v112, v112
    v_exp_f32 v113, v113
    v_mfma_f32_32x32x16_bf16 v[184:199], v[92:95], v[148:151], v[184:199]
    v_exp_f32 v114, v114
    v_exp_f32 v115, v115
    v_cvt_pk_bf16_f32 v144, v112, v113
    v_cvt_pk_bf16_f32 v145, v114, v115
    v_mfma_f32_32x32x16_bf16 v[128:143], v[36:39], v[168:171], 0
    v_exp_f32 v116, v116
    v_exp_f32 v117, v117
    v_exp_f32 v118, v118
    v_exp_f32 v119, v119
    v_cvt_pk_bf16_f32 v146, v116, v117
    v_cvt_pk_bf16_f32 v147, v118, v119
    v_mfma_f32_32x32x8_bf16 v[128:143], v[46:47], v[174:175], v[128:143]
    v_exp_f32 v120, v120
    v_exp_f32 v121, v121
    v_exp_f32 v122, v122
    v_exp_f32 v123, v123
    v_cvt_pk_bf16_f32 v148, v120, v121
    v_cvt_pk_bf16_f32 v149, v122, v123
    v_bfe_u32 v200, v192, 23, 8
    v_add_u32 v200, -71, v200
    v_mov_b32 v201, 120
    v_med3_i32 v200, v200, 0, v201
    v_mul_u32_u24 v200, v200, v3
    v_sub_u32 v201, 0, v200
    v_cvt_f32_i32 v201, v201
    v_sub_u32 v202, 127, v200
    v_lshlrev_b32 v202, 23, v202
    v_mov_b32 v220, v202
    v_or_b32 v173, v173, v201
    v_or_b32 v174, v174, v201
    v_mov_b32 v201, 1
    v_permlane32_swap_b32 v202, v220
    ds_write_b128 v6, v[172:175] offset:1024
    ds_write_b32 v221, v201
    v_mfma_f32_32x32x16_bf16 v[184:199], v[96:99], v[144:147], v[184:199]
    v_exp_f32 v124, v124
    v_exp_f32 v125, v125
    v_exp_f32 v126, v126
    v_exp_f32 v127, v127
    v_cvt_pk_bf16_f32 v150, v124, v125
    v_cvt_pk_bf16_f32 v151, v126, v127
    v_xor_b32 v6, 2048, v6
    v_xor_b32 v221, 4, v221
    ds_read_b32 v222, v221
    ds_read_b128 v[176:179], v6 offset:0
    ds_read_b128 v[180:183], v6 offset:1024
    v_exp_f32 v128, v128
    v_exp_f32 v129, v129
    v_mfma_f32_32x32x16_bf16 v[184:199], v[100:103], v[148:151], v[184:199]
    v_exp_f32 v130, v130
    v_exp_f32 v131, v131
    v_cvt_pk_bf16_f32 v144, v128, v129
    v_cvt_pk_bf16_f32 v145, v130, v131
L_qc0:
    s_waitcnt lgkmcnt(0)
    v_readfirstlane_b32 s24, v222
    s_setprio 2
    s_cmp_eq_u32 s24, 0
    s_cbranch_scc1 L_qs0
    v_mfma_f32_32x32x16_bf16 v[112:127], v[8:11], v[176:179], 0
    v_exp_f32 v132, v132
    v_exp_f32 v133, v133
    v_exp_f32 v134, v134
    v_exp_f32 v135, v135
    v_cvt_pk_bf16_f32 v146, v132, v133
    v_cvt_pk_bf16_f32 v147, v134, v135
    v_mfma_f32_32x32x8_bf16 v[112:127], v[40:41], v[180:181], v[112:127]
    v_exp_f32 v136, v136
    v_exp_f32 v137, v137
    v_exp_f32 v138, v138
    v_exp_f32 v139, v139
    v_cvt_pk_bf16_f32 v148, v136, v137
    v_cvt_pk_bf16_f32 v149, v138, v139
    v_mfma_f32_32x32x16_bf16 v[184:199], v[104:107], v[144:147], v[184:199]
    v_exp_f32 v140, v140
    v_exp_f32 v141, v141
    v_exp_f32 v142, v142
    v_exp_f32 v143, v143
    v_cvt_pk_bf16_f32 v150, v140, v141
    v_cvt_pk_bf16_f32 v151, v142, v143
    v_exp_f32 v112, v112
    v_exp_f32 v113, v113
    v_mfma_f32_32x32x16_bf16 v[184:199], v[108:111], v[148:151], v[184:199]
    v_exp_f32 v114, v114
    v_exp_f32 v115, v115
    v_cvt_pk_bf16_f32 v144, v112, v113
    v_cvt_pk_bf16_f32 v145, v114, v115
    v_mfma_f32_32x32x16_bf16 v[128:143], v[12:15], v[176:179], 0
    v_exp_f32 v116, v116
    v_exp_f32 v117, v117
    v_exp_f32 v118, v118
    v_exp_f32 v119, v119
    v_cvt_pk_bf16_f32 v146, v116, v117
    v_cvt_pk_bf16_f32 v147, v118, v119
    v_mfma_f32_32x32x8_bf16 v[128:143], v[40:41], v[182:183], v[128:143]
    v_exp_f32 v120, v120
    v_exp_f32 v121, v121
    v_exp_f32 v122, v122
    v_exp_f32 v123, v123
    v_cvt_pk_bf16_f32 v148, v120, v121
    v_cvt_pk_bf16_f32 v149, v122, v123
    v_mfma_f32_32x32x16_bf16 v[152:167], v[48:51], v[144:147], 0
    v_exp_f32 v124, v124
    v_exp_f32 v125, v125
    v_exp_f32 v126, v126
    v_exp_f32 v127, v127
    v_cvt_pk_bf16_f32 v150, v124, v125
    v_cvt_pk_bf16_f32 v151, v126, v127
    s_cmp_lt_u32 s52, 2
    s_cbranch_scc1 L_ha_x
    s_cmp_eq_u32 s52, 2
    s_cbranch_scc0 L_ha_2
    buffer_load_dwordx4 v[200:203], v219, s[48:51], s53 offen offset:0
    buffer_load_dwordx4 v[204:207], v219, s[48:51], s53 offen offset:16
    buffer_load_dwordx4 v[208:211], v219, s[48:51], s53 offen offset:64
    buffer_load_dwordx4 v[212:215], v219, s[48:51], s53 offen offset:80
    buffer_load_dwordx4 v[240:243], v219, s[48:51], s53 offen offset:128
    buffer_load_dwordx4 v[244:247], v219, s[48:51], s53 offen offset:144
    s_branch L_ha_x
L_ha_2:
    s_cmp_eq_u32 s52, 3
    s_mov_b32 s52, 0
    s_cbranch_scc1 L_ha_3
    v_mov_b32 v215, 1
    v_mov_b32 v214, 160832
    s_mov_b64 exec, 1
    ds_add_rtn_u32 v214, v214, v215
    s_waitcnt lgkmcnt(0)
    v_readfirstlane_b32 s24, v214
    s_cmp_lg_u32 s24, 3
    s_cbranch_scc1 L_jd2
    buffer_store_dword v0, v223, s[8:11], s35 offen offset:8 sc1
L_jd2:
    s_mov_b64 exec, -1
    s_branch L_ha_x
L_ha_3:
    buffer_load_dwordx4 v[200:203], v4, s[48:51], s53 offen offset:0
    buffer_load_dwordx4 v[200:203], v4, s[48:51], s53 offen offset:1024
    buffer_load_dwordx4 v[200:203], v4, s[48:51], s53 offen offset:2048
    buffer_load_dwordx4 v[200:203], v4, s[48:51], s53 offen offset:3072
    s_add_u32 s53, s53, 4096
    buffer_load_dwordx4 v[200:203], v4, s[48:51], s53 offen offset:0
    buffer_load_dwordx4 v[200:203], v4, s[48:51], s53 offen offset:1024
    buffer_load_dwordx4 v[200:203], v4, s[48:51], s53 offen offset:2048
    buffer_load_dwordx4 v[200:203], v4, s[48:51], s53 offen offset:3072
    s_add_u32 s53, s53, 4096
    buffer_load_dwordx4 v[200:203], v4, s[48:51], s53 offen offset:0
    buffer_load_dwordx4 v[200:203], v4, s[48:51], s53 offen offset:1024
    buffer_load_dwordx4 v[200:203], v4, s[48:51], s53 offen offset:2048
    buffer_load_dwordx4 v[200:203], v4, s[48:51], s53 offen offset:3072
    s_add_u32 s53, s53, 4096
    buffer_load_dwordx4 v[200:203], v4, s[48:51], s53 offen offset:0
    buffer_load_dwordx4 v[200:203], v4, s[48:51], s53 offen offset:1024
    buffer_load_dwordx4 v[200:203], v4, s[48:51], s53 offen offset:2048
    buffer_load_dwordx4 v[200:203], v4, s[48:51], s53 offen offset:3072
    s_add_u32 s53, s53, 4096
    buffer_load_dwordx4 v[200:203], v4, s[48:51], s53 offen offset:0
    buffer_load_dwordx4 v[200:203], v4, s[48:51], s53 offen offset:1024
    buffer_load_dwordx4 v[200:203], v4, s[48:51], s53 offen offset:2048
    buffer_load_dwordx4 v[200:203], v4, s[48:51], s53 offen offset:3072
    s_add_u32 s53, s53, 4096
    buffer_load_dwordx4 v[200:203], v4, s[48:51], s53 offen offset:0
L_ha_x:
    v_exp_f32 v128, v128
    v_exp_f32 v129, v129
    v_mfma_f32_32x32x16_bf16 v[152:167], v[52:55], v[148:151], v[152:167]
    v_exp_f32 v130, v130
    v_exp_f32 v131, v131
    v_cvt_pk_bf16_f32 v144, v128, v129
    v_cvt_pk_bf16_f32 v145, v130, v131
    v_mfma_f32_32x32x16_bf16 v[112:127], v[16:19], v[176:179], 0
    v_exp_f32 v132, v132
    v_exp_f32 v133, v133
    v_exp_f32 v134, v134
    v_exp_f32 v135, v135
    v_cvt_pk_bf16_f32 v146, v132, v133
    v_cvt_pk_bf16_f32 v147, v134, v135
    v_mfma_f32_32x32x8_bf16 v[112:127], v[42:43], v[180:181], v[112:127]
    v_exp_f32 v136, v136
    v_exp_f32 v137, v137
    v_exp_f32 v138, v138
    v_exp_f32 v139, v139
    v_cvt_pk_bf16_f32 v148, v136, v137
    v_cvt_pk_bf16_f32 v149, v138, v139
    v_mfma_f32_32x32x16_bf16 v[152:167], v[56:59], v[144:147], v[152:167]
    v_exp_f32 v140, v140
    v_exp_f32 v141, v141
    v_exp_f32 v142, v142
    v_exp_f32 v143, v143
    v_cvt_pk_bf16_f32 v150, v140, v141
    v_cvt_pk_bf16_f32 v151, v142, v143
    v_xor_b32 v6, 6144, v6
    v_xor_b32 v221, 12, v221
    ds_read_b32 v222, v221
    ds_read_b128 v[168:171], v6 offset:0
    ds_read_b128 v[172:175], v6 offset:1024
    v_exp_f32 v112, v112
    v_exp_f32 v113, v113
    v_mfma_f32_32x32x16_bf16 v[152:167], v[60:63], v[148:151], v[152:167]
    v_exp_f32 v114, v114
    v_exp_f32 v115, v115
    v_cvt_pk_bf16_f32 v144, v112, v113
    v_cvt_pk_bf16_f32 v145, v114, v115
    v_mfma_f32_32x32x16_bf16 v[128:143], v[20:23], v[176:179], 0
    v_exp_f32 v116, v116
    v_exp_f32 v117, v117
    v_exp_f32 v118, v118
    v_exp_f32 v119, v119
    v_cvt_pk_bf16_f32 v146, v116, v117
    v_cvt_pk_bf16_f32 v147, v118, v119
    v_mfma_f32_32x32x8_bf16 v[128:143], v[42:43], v[182:183], v[128:143]
    v_exp_f32 v120, v120
    v_exp_f32 v121, v121
    v_exp_f32 v122, v122
    v_exp_f32 v123, v123
    v_cvt_pk_bf16_f32 v148, v120, v121
    v_cvt_pk_bf16_f32 v149, v122, v123
    v_mfma_f32_32x32x16_bf16 v[152:167], v[64:67], v[144:147], v[152:167]
    v_exp_f32 v124, v124
    v_exp_f32 v125, v125
    v_exp_f32 v126, v126
    v_exp_f32 v127, v127
    v_cvt_pk_bf16_f32 v150, v124, v125
    v_cvt_pk_bf16_f32 v151, v126, v127
    v_exp_f32 v128, v128
    v_exp_f32 v129, v129
    v_mfma_f32_32x32x16_bf16 v[152:167], v[68:71], v[148:151], v[152:167]
    v_exp_f32 v130, v130
    v_exp_f32 v131, v131
    v_cvt_pk_bf16_f32 v144, v128, v129
    v_cvt_pk_bf16_f32 v145, v130, v131
    v_mfma_f32_32x32x16_bf16 v[112:127], v[24:27], v[176:179], 0
    v_exp_f32 v132, v132
    v_exp_f32 v133, v133
    v_exp_f32 v134, v134
    v_exp_f32 v135, v135
    v_cvt_pk_bf16_f32 v146, v132, v133
    v_cvt_pk_bf16_f32 v147, v134, v135
    v_mfma_f32_32x32x8_bf16 v[112:127], v[44:45], v[180:181], v[112:127]
    v_exp_f32 v136, v136
    v_exp_f32 v137, v137
    v_exp_f32 v138, v138
    v_exp_f32 v139, v139
    v_cvt_pk_bf16_f32 v148, v136, v137
    v_cvt_pk_bf16_f32 v149, v138, v139
    v_mfma_f32_32x32x16_bf16 v[152:167], v[72:75], v[144:147], v[152:167]
    v_exp_f32 v140, v140
    v_exp_f32 v141, v141
    v_exp_f32 v142, v142
    v_exp_f32 v143, v143
    v_cvt_pk_bf16_f32 v150, v140, v141
    v_cvt_pk_bf16_f32 v151, v142, v143
    v_exp_f32 v112, v112
    v_exp_f32 v113, v113
    v_mfma_f32_32x32x16_bf16 v[152:167], v[76:79], v[148:151], v[152:167]
    v_exp_f32 v114, v114
    v_exp_f32 v115, v115
    v_cvt_pk_bf16_f32 v144, v112, v113
    v_cvt_pk_bf16_f32 v145, v114, v115
    v_mfma_f32_32x32x16_bf16 v[128:143], v[28:31], v[176:179], 0
    v_exp_f32 v116, v116
    v_exp_f32 v117, v117
    v_exp_f32 v118, v118
    v_exp_f32 v119, v119
    v_cvt_pk_bf16_f32 v146, v116, v117
    v_cvt_pk_bf16_f32 v147, v118, v119
    v_mfma_f32_32x32x8_bf16 v[128:143], v[44:45], v[182:183], v[128:143]
    v_exp_f32 v120, v120
    v_exp_f32 v121, v121
    v_exp_f32 v122, v122
    v_exp_f32 v123, v123
    v_cvt_pk_bf16_f32 v148, v120, v121
    v_cvt_pk_bf16_f32 v149, v122, v123
    v_mfma_f32_32x32x16_bf16 v[152:167], v[80:83], v[144:147], v[152:167]
    v_exp_f32 v124, v124
    v_exp_f32 v125, v125
    v_exp_f32 v126, v126
    v_exp_f32 v127, v127
    v_cvt_pk_bf16_f32 v150, v124, v125
    v_cvt_pk_bf16_f32 v151, v126, v127
    v_exp_f32 v128, v128
    v_exp_f32 v129, v129
    v_mfma_f32_32x32x16_bf16 v[152:167], v[84:87], v[148:151], v[152:167]
    v_exp_f32 v130, v130
    v_exp_f32 v131, v131
    v_cvt_pk_bf16_f32 v144, v128, v129
    v_cvt_pk_bf16_f32 v145, v130, v131
    v_mfma_f32_32x32x16_bf16 v[112:127], v[32:35], v[176:179], 0
    v_exp_f32 v132, v132
    v_exp_f32 v133, v133
    v_exp_f32 v134, v134
    v_exp_f32 v135, v135
    v_cvt_pk_bf16_f32 v146, v132, v133
    v_cvt_pk_bf16_f32 v147, v134, v135
    v_mfma_f32_32x32x8_bf16 v[112:127], v[46:47], v[180:181], v[112:127]
    v_exp_f32 v136, v136
    v_exp_f32 v137, v137
    v_exp_f32 v138, v138
    v_exp_f32 v139, v139
    v_cvt_pk_bf16_f32 v148, v136, v137
    v_cvt_pk_bf16_f32 v149, v138, v139
    v_mfma_f32_32x32x16_bf16 v[152:167], v[88:91], v[144:147], v[152:167]
    v_exp_f32 v140, v140
    v_exp_f32 v141, v141
    v_exp_f32 v142, v142
    v_exp_f32 v143, v143
    v_cvt_pk_bf16_f32 v150, v140, v141
    v_cvt_pk_bf16_f32 v151, v142, v143
    v_exp_f32 v112, v112
    v_exp_f32 v113, v113
    v_mfma_f32_32x32x16_bf16 v[152:167], v[92:95], v[148:151], v[152:167]
    v_exp_f32 v114, v114
    v_exp_f32 v115, v115
    v_cvt_pk_bf16_f32 v144, v112, v113
    v_cvt_pk_bf16_f32 v145, v114, v115
    v_mfma_f32_32x32x16_bf16 v[128:143], v[36:39], v[176:179], 0
    v_exp_f32 v116, v116
    v_exp_f32 v117, v117
    v_exp_f32 v118, v118
    v_exp_f32 v119, v119
    v_cvt_pk_bf16_f32 v146, v116, v117
    v_cvt_pk_bf16_f32 v147, v118, v119
    v_mfma_f32_32x32x8_bf16 v[128:143], v[46:47], v[182:183], v[128:143]
    v_exp_f32 v120, v120
    v_exp_f32 v121, v121
    v_exp_f32 v122, v122
    v_exp_f32 v123, v123
    v_cvt_pk_bf16_f32 v148, v120, v121
    v_cvt_pk_bf16_f32 v149, v122, v123
    v_mfma_f32_32x32x16_bf16 v[152:167], v[96:99], v[144:147], v[152:167]
    v_exp_f32 v124, v124
    v_exp_f32 v125, v125
    v_exp_f32 v126, v126
    v_exp_f32 v127, v127
    v_cvt_pk_bf16_f32 v150, v124, v125
    v_cvt_pk_bf16_f32 v151, v126, v127
    v_exp_f32 v128, v128
    v_exp_f32 v129, v129
    v_mfma_f32_32x32x16_bf16 v[152:167], v[100:103], v[148:151], v[152:167]
    v_exp_f32 v130, v130
    v_exp_f32 v131, v131
    v_cvt_pk_bf16_f32 v144, v128, v129
    v_cvt_pk_bf16_f32 v145, v130, v131
L_qc1:
    s_waitcnt lgkmcnt(0)
    v_readfirstlane_b32 s24, v222
    s_cmp_eq_u32 s24, 0
    s_cbranch_scc1 L_qs1
    v_mfma_f32_32x32x16_bf16 v[112:127], v[8:11], v[168:171], 0
    v_exp_f32 v132, v132
    v_exp_f32 v133, v133
    v_exp_f32 v134, v134
    v_exp_f32 v135, v135
    v_cvt_pk_bf16_f32 v146, v132, v133
    v_cvt_pk_bf16_f32 v147, v134, v135
    v_mfma_f32_32x32x8_bf16 v[112:127], v[40:41], v[172:173], v[112:127]
    v_exp_f32 v136, v136
    v_exp_f32 v137, v137
    v_exp_f32 v138, v138
    v_exp_f32 v139, v139
    v_cvt_pk_bf16_f32 v148, v136, v137
    v_cvt_pk_bf16_f32 v149, v138, v139
    v_mfma_f32_32x32x16_bf16 v[152:167], v[104:107], v[144:147], v[152:167]
    v_exp_f32 v140, v140
    v_exp_f32 v141, v141
    v_exp_f32 v142, v142
    v_exp_f32 v143, v143
    v_cvt_pk_bf16_f32 v150, v140, v141
    v_cvt_pk_bf16_f32 v151, v142, v143
    s_cmp_eq_u32 s52, 1
    s_cbranch_scc1 L_job12
    v_exp_f32 v112, v112
    v_exp_f32 v113, v113
    v_mfma_f32_32x32x16_bf16 v[152:167], v[108:111], v[148:151], v[152:167]
    v_exp_f32 v114, v114
    v_exp_f32 v115, v115
    v_cvt_pk_bf16_f32 v144, v112, v113
    v_cvt_pk_bf16_f32 v145, v114, v115
    s_xor_b32 s24, s12, 1
    s_mul_i32 s24, s24, 17920
    s_add_u32 s24, s24, 16384
    v_add_u32 v7, s24, v4
    v_add_u32 v217, s24, v5
    v_mfma_f32_32x32x16_bf16 v[128:143], v[12:15], v[168:171], 0
    v_exp_f32 v116, v116
    v_exp_f32 v117, v117
    v_exp_f32 v118, v118
    v_exp_f32 v119, v119
    v_cvt_pk_bf16_f32 v146, v116, v117
    v_cvt_pk_bf16_f32 v147, v118, v119
    v_mfma_f32_32x32x8_bf16 v[128:143], v[40:41], v[174:175], v[128:143]
    v_exp_f32 v120, v120
    ds_write_b128 v7, v[152:155]
    v_exp_f32 v121, v121
    ds_write_b128 v7, v[156:159] offset:1024
    v_exp_f32 v122, v122
    ds_write_b64 v217, v[160:161] offset:2048
    v_exp_f32 v123, v123
    v_cvt_pk_bf16_f32 v148, v120, v121
    v_cvt_pk_bf16_f32 v149, v122, v123
    v_mfma_f32_32x32x16_bf16 v[152:167], v[48:51], v[144:147], 0
    v_exp_f32 v124, v124
    v_exp_f32 v125, v125
    v_exp_f32 v126, v126
    v_exp_f32 v127, v127
    v_cvt_pk_bf16_f32 v150, v124, v125
    v_cvt_pk_bf16_f32 v151, v126, v127
    v_exp_f32 v128, v128
    v_exp_f32 v129, v129
    v_mfma_f32_32x32x16_bf16 v[152:167], v[52:55], v[148:151], v[152:167]
    v_exp_f32 v130, v130
    v_exp_f32 v131, v131
    v_cvt_pk_bf16_f32 v144, v128, v129
    v_cvt_pk_bf16_f32 v145, v130, v131
    v_mfma_f32_32x32x16_bf16 v[112:127], v[16:19], v[168:171], 0
    v_exp_f32 v132, v132
    v_exp_f32 v133, v133
    v_exp_f32 v134, v134
    v_exp_f32 v135, v135
    v_cvt_pk_bf16_f32 v146, v132, v133
    v_cvt_pk_bf16_f32 v147, v134, v135
    v_mfma_f32_32x32x8_bf16 v[112:127], v[42:43], v[172:173], v[112:127]
    v_exp_f32 v136, v136
    v_exp_f32 v137, v137
    v_exp_f32 v138, v138
    v_exp_f32 v139, v139
    v_cvt_pk_bf16_f32 v148, v136, v137
    v_cvt_pk_bf16_f32 v149, v138, v139
    v_mfma_f32_32x32x16_bf16 v[152:167], v[56:59], v[144:147], v[152:167]
    v_exp_f32 v140, v140
    v_exp_f32 v141, v141
    v_exp_f32 v142, v142
    v_exp_f32 v143, v143
    v_cvt_pk_bf16_f32 v150, v140, v141
    v_cvt_pk_bf16_f32 v151, v142, v143
    v_xor_b32 v6, 2048, v6
    v_xor_b32 v221, 4, v221
    ds_read_b32 v222, v221
    ds_read_b128 v[176:179], v6 offset:0
    ds_read_b128 v[180:183], v6 offset:1024
    v_exp_f32 v112, v112
    v_exp_f32 v113, v113
    v_mfma_f32_32x32x16_bf16 v[152:167], v[60:63], v[148:151], v[152:167]
    v_exp_f32 v114, v114
    v_exp_f32 v115, v115
    v_cvt_pk_bf16_f32 v144, v112, v113
    v_cvt_pk_bf16_f32 v145, v114, v115
    v_mfma_f32_32x32x16_bf16 v[128:143], v[20:23], v[168:171], 0
    v_exp_f32 v116, v116
    v_exp_f32 v117, v117
    v_exp_f32 v118, v118
    v_exp_f32 v119, v119
    v_cvt_pk_bf16_f32 v146, v116, v117
    v_cvt_pk_bf16_f32 v147, v118, v119
    v_mfma_f32_32x32x8_bf16 v[128:143], v[42:43], v[174:175], v[128:143]
    v_exp_f32 v120, v120
    v_exp_f32 v121, v121
    v_exp_f32 v122, v122
    v_exp_f32 v123, v123
    v_cvt_pk_bf16_f32 v148, v120, v121
    v_cvt_pk_bf16_f32 v149, v122, v123
    v_mfma_f32_32x32x16_bf16 v[152:167], v[64:67], v[144:147], v[152:167]
    v_exp_f32 v124, v124
    v_exp_f32 v125, v125
    v_exp_f32 v126, v126
    v_exp_f32 v127, v127
    v_cvt_pk_bf16_f32 v150, v124, v125
    v_cvt_pk_bf16_f32 v151, v126, v127
    v_exp_f32 v128, v128
    v_exp_f32 v129, v129
    v_mfma_f32_32x32x16_bf16 v[152:167], v[68:71], v[148:151], v[152:167]
    v_exp_f32 v130, v130
    v_exp_f32 v131, v131
    v_cvt_pk_bf16_f32 v144, v128, v129
    v_cvt_pk_bf16_f32 v145, v130, v131
    v_mfma_f32_32x32x16_bf16 v[112:127], v[24:27], v[168:171], 0
    v_exp_f32 v132, v132
    v_exp_f32 v133, v133
    v_exp_f32 v134, v134
    v_exp_f32 v135, v135
    v_cvt_pk_bf16_f32 v146, v132, v133
    v_cvt_pk_bf16_f32 v147, v134, v135
    v_mfma_f32_32x32x8_bf16 v[112:127], v[44:45], v[172:173], v[112:127]
    v_exp_f32 v136, v136
    v_exp_f32 v137, v137
    v_exp_f32 v138, v138
    v_exp_f32 v139, v139
    v_cvt_pk_bf16_f32 v148, v136, v137
    v_cvt_pk_bf16_f32 v149, v138, v139
    v_mfma_f32_32x32x16_bf16 v[152:167], v[72:75], v[144:147], v[152:167]
    v_exp_f32 v140, v140
    v_exp_f32 v141, v141
    v_exp_f32 v142, v142
    v_exp_f32 v143, v143
    v_cvt_pk_bf16_f32 v150, v140, v141
    v_cvt_pk_bf16_f32 v151, v142, v143
    v_exp_f32 v112, v112
    v_exp_f32 v113, v113
    v_mfma_f32_32x32x16_bf16 v[152:167], v[76:79], v[148:151], v[152:167]
    v_exp_f32 v114, v114
    v_exp_f32 v115, v115
    v_cvt_pk_bf16_f32 v144, v112, v113
    v_cvt_pk_bf16_f32 v145, v114, v115
    v_mfma_f32_32x32x16_bf16 v[128:143], v[28:31], v[168:171], 0
    v_exp_f32 v116, v116
    v_exp_f32 v117, v117
    v_exp_f32 v118, v118
    v_exp_f32 v119, v119
    v_cvt_pk_bf16_f32 v146, v116, v117
    v_cvt_pk_bf16_f32 v147, v118, v119
    v_mfma_f32_32x32x8_bf16 v[128:143], v[44:45], v[174:175], v[128:143]
    v_exp_f32 v120, v120
    v_exp_f32 v121, v121
    v_exp_f32 v122, v122
    v_exp_f32 v123, v123
    v_cvt_pk_bf16_f32 v148, v120, v121
    v_cvt_pk_bf16_f32 v149, v122, v123
    v_mfma_f32_32x32x16_bf16 v[152:167], v[80:83], v[144:147], v[152:167]
    v_exp_f32 v124, v124
    v_exp_f32 v125, v125
    v_exp_f32 v126, v126
    v_exp_f32 v127, v127
    v_cvt_pk_bf16_f32 v150, v124, v125
    v_cvt_pk_bf16_f32 v151, v126, v127
    v_exp_f32 v128, v128
    v_exp_f32 v129, v129
    v_mfma_f32_32x32x16_bf16 v[152:167], v[84:87], v[148:151], v[152:167]
    v_exp_f32 v130, v130
    v_exp_f32 v131, v131
    v_cvt_pk_bf16_f32 v144, v128, v129
    v_cvt_pk_bf16_f32 v145, v130, v131
    v_mfma_f32_32x32x16_bf16 v[112:127], v[32:35], v[168:171], 0
    v_exp_f32 v132, v132
    v_exp_f32 v133, v133
    v_exp_f32 v134, v134
    v_exp_f32 v135, v135
    v_cvt_pk_bf16_f32 v146, v132, v133
    v_cvt_pk_bf16_f32 v147, v134, v135
    v_mfma_f32_32x32x8_bf16 v[112:127], v[46:47], v[172:173], v[112:127]
    v_exp_f32 v136, v136
    v_exp_f32 v137, v137
    v_exp_f32 v138, v138
    v_exp_f32 v139, v139
    v_cvt_pk_bf16_f32 v148, v136, v137
    v_cvt_pk_bf16_f32 v149, v138, v139
    v_mfma_f32_32x32x16_bf16 v[152:167], v[88:91], v[144:147], v[152:167]
    v_exp_f32 v140, v140
    v_exp_f32 v141, v141
    v_exp_f32 v142, v142
    v_exp_f32 v143, v143
    v_cvt_pk_bf16_f32 v150, v140, v141
    v_cvt_pk_bf16_f32 v151, v142, v143
    s_cmp_eq_u32 s52, 2
    s_cbranch_scc0 L_hb_x
    s_mov_b32 s24, 0x05040100
    s_mov_b32 s25, 0x07060302
    s_add_u32 s21, s55, 17408
    s_waitcnt vmcnt(0)
    v_perm_b32 v224, v201, v200, s24
    v_perm_b32 v228, v201, v200, s25
    v_perm_b32 v225, v203, v202, s24
    v_perm_b32 v229, v203, v202, s25
    v_perm_b32 v226, v205, v204, s24
    v_perm_b32 v230, v205, v204, s25
    v_perm_b32 v227, v207, v206, s24
    v_perm_b32 v231, v207, v206, s25
    buffer_store_dwordx4 v[224:227], v4, s[8:11], s55 offen offset:0 sc1
    buffer_store_dwordx4 v[228:231], v4, s[8:11], s21 offen offset:0 sc1
    v_perm_b32 v232, v209, v208, s24
    v_perm_b32 v236, v209, v208, s25
    v_perm_b32 v233, v211, v210, s24
    v_perm_b32 v237, v211, v210, s25
    v_perm_b32 v234, v213, v212, s24
    v_perm_b32 v238, v213, v212, s25
    v_perm_b32 v235, v215, v214, s24
    v_perm_b32 v239, v215, v214, s25
    buffer_store_dwordx4 v[232:235], v4, s[8:11], s55 offen offset:1024 sc1
    buffer_store_dwordx4 v[236:239], v4, s[8:11], s21 offen offset:1024 sc1
    s_cmp_eq_u32 s54, 15
    s_cbranch_scc1 L_hb_x
    v_perm_b32 v224, v241, v240, s24
    v_perm_b32 v228, v241, v240, s25
    v_perm_b32 v225, v243, v242, s24
    v_perm_b32 v229, v243, v242, s25
    v_perm_b32 v226, v245, v244, s24
    v_perm_b32 v230, v245, v244, s25
    v_perm_b32 v227, v247, v246, s24
    v_perm_b32 v231, v247, v246, s25
    buffer_store_dwordx4 v[224:227], v4, s[8:11], s55 offen offset:2048 sc1
    buffer_store_dwordx4 v[228:231], v4, s[8:11], s21 offen offset:2048 sc1
L_hb_x:
    v_exp_f32 v112, v112
    v_exp_f32 v113, v113
    v_mfma_f32_32x32x16_bf16 v[152:167], v[92:95], v[148:151], v[152:167]
    v_exp_f32 v114, v114
    v_exp_f32 v115, v115
    v_cvt_pk_bf16_f32 v144, v112, v113
    v_cvt_pk_bf16_f32 v145, v114, v115
    v_mfma_f32_32x32x16_bf16 v[128:143], v[36:39], v[168:171], 0
    v_exp_f32 v116, v116
    v_exp_f32 v117, v117
    v_exp_f32 v118, v118
    v_exp_f32 v119, v119
    v_cvt_pk_bf16_f32 v146, v116, v117
    v_cvt_pk_bf16_f32 v147, v118, v119
    v_mfma_f32_32x32x8_bf16 v[128:143], v[46:47], v[174:175], v[128:143]
    v_exp_f32 v120, v120
    v_exp_f32 v121, v121
    v_exp_f32 v122, v122
    v_exp_f32 v123, v123
    v_cvt_pk_bf16_f32 v148, v120, v121
    v_cvt_pk_bf16_f32 v149, v122, v123
    v_mfma_f32_32x32x16_bf16 v[152:167], v[96:99], v[144:147], v[152:167]
    v_exp_f32 v124, v124
    v_exp_f32 v125, v125
    v_exp_f32 v126, v126
    v_exp_f32 v127, v127
    v_cvt_pk_bf16_f32 v150, v124, v125
    v_cvt_pk_bf16_f32 v151, v126, v127
    v_exp_f32 v128, v128
    v_exp_f32 v129, v129
    v_mfma_f32_32x32x16_bf16 v[152:167], v[100:103], v[148:151], v[152:167]
    v_exp_f32 v130, v130
    v_exp_f32 v131, v131
    v_cvt_pk_bf16_f32 v144, v128, v129
    v_cvt_pk_bf16_f32 v145, v130, v131
L_qc2:
    s_waitcnt lgkmcnt(0)
    v_readfirstlane_b32 s24, v222
    s_cmp_eq_u32 s24, 0
    s_cbranch_scc1 L_qs2
    v_mfma_f32_32x32x16_bf16 v[112:127], v[8:11], v[176:179], 0
    v_exp_f32 v132, v132
    v_exp_f32 v133, v133
    v_exp_f32 v134, v134
    v_exp_f32 v135, v135
    v_cvt_pk_bf16_f32 v146, v132, v133
    v_cvt_pk_bf16_f32 v147, v134, v135
    v_mfma_f32_32x32x8_bf16 v[112:127], v[40:41], v[180:181], v[112:127]
    v_exp_f32 v136, v136
    v_exp_f32 v137, v137
    v_exp_f32 v138, v138
    v_exp_f32 v139, v139
    v_cvt_pk_bf16_f32 v148, v136, v137
    v_cvt_pk_bf16_f32 v149, v138, v139
    v_mfma_f32_32x32x16_bf16 v[152:167], v[104:107], v[144:147], v[152:167]
    v_exp_f32 v140, v140
    v_exp_f32 v141, v141
    v_exp_f32 v142, v142
    v_exp_f32 v143, v143
    v_cvt_pk_bf16_f32 v150, v140, v141
    v_cvt_pk_bf16_f32 v151, v142, v143
    v_exp_f32 v112, v112
    v_exp_f32 v113, v113
    v_mfma_f32_32x32x16_bf16 v[152:167], v[108:111], v[148:151], v[152:167]
    v_exp_f32 v114, v114
    v_exp_f32 v115, v115
    v_cvt_pk_bf16_f32 v144, v112, v113
    v_cvt_pk_bf16_f32 v145, v114, v115
    s_xor_b32 s24, s12, 2
    s_mul_i32 s24, s24, 17920
    s_add_u32 s24, s24, 18944
    v_add_u32 v7, s24, v4
    v_add_u32 v217, s24, v5
    v_mfma_f32_32x32x16_bf16 v[128:143], v[12:15], v[176:179], 0
    v_exp_f32 v116, v116
    v_exp_f32 v117, v117
    v_exp_f32 v118, v118
    v_exp_f32 v119, v119
    v_cvt_pk_bf16_f32 v146, v116, v117
    v_cvt_pk_bf16_f32 v147, v118, v119
    v_mfma_f32_32x32x8_bf16 v[128:143], v[40:41], v[182:183], v[128:143]
    v_exp_f32 v120, v120
    ds_write_b128 v7, v[152:155]
    v_exp_f32 v121, v121
    ds_write_b128 v7, v[156:159] offset:1024
    v_exp_f32 v122, v122
    ds_write_b64 v217, v[160:161] offset:2048
    v_exp_f32 v123, v123
    v_cvt_pk_bf16_f32 v148, v120, v121
    v_cvt_pk_bf16_f32 v149, v122, v123
    v_mfma_f32_32x32x16_bf16 v[152:167], v[48:51], v[144:147], 0
    v_exp_f32 v124, v124
    v_exp_f32 v125, v125
    v_exp_f32 v126, v126
    v_exp_f32 v127, v127
    v_cvt_pk_bf16_f32 v150, v124, v125
    v_cvt_pk_bf16_f32 v151, v126, v127
    v_exp_f32 v128, v128
    v_exp_f32 v129, v129
    v_mfma_f32_32x32x16_bf16 v[152:167], v[52:55], v[148:151], v[152:167]
    v_exp_f32 v130, v130
    v_exp_f32 v131, v131
    v_cvt_pk_bf16_f32 v144, v128, v129
    v_cvt_pk_bf16_f32 v145, v130, v131
    v_mfma_f32_32x32x16_bf16 v[112:127], v[16:19], v[176:179], 0
    v_exp_f32 v132, v132
    v_exp_f32 v133, v133
    v_exp_f32 v134, v134
    v_exp_f32 v135, v135
    v_cvt_pk_bf16_f32 v146, v132, v133
    v_cvt_pk_bf16_f32 v147, v134, v135
    v_mfma_f32_32x32x8_bf16 v[112:127], v[42:43], v[180:181], v[112:127]
    v_exp_f32 v136, v136
    v_exp_f32 v137, v137
    v_exp_f32 v138, v138
    v_exp_f32 v139, v139
    v_cvt_pk_bf16_f32 v148, v136, v137
    v_cvt_pk_bf16_f32 v149, v138, v139
    v_mfma_f32_32x32x16_bf16 v[152:167], v[56:59], v[144:147], v[152:167]
    v_exp_f32 v140, v140
    v_exp_f32 v141, v141
    v_exp_f32 v142, v142
    v_exp_f32 v143, v143
    v_cvt_pk_bf16_f32 v150, v140, v141
    v_cvt_pk_bf16_f32 v151, v142, v143
    v_xor_b32 v6, 14336, v6
    v_xor_b32 v221, 28, v221
    ds_read_b32 v222, v221
    ds_read_b128 v[168:171], v6 offset:0
    ds_read_b128 v[172:175], v6 offset:1024
    v_exp_f32 v112, v112
    v_exp_f32 v113, v113
    v_mfma_f32_32x32x16_bf16 v[152:167], v[60:63], v[148:151], v[152:167]
    v_exp_f32 v114, v114
    v_exp_f32 v115, v115
    v_cvt_pk_bf16_f32 v144, v112, v113
    v_cvt_pk_bf16_f32 v145, v114, v115
    v_mfma_f32_32x32x16_bf16 v[128:143], v[20:23], v[176:179], 0
    v_exp_f32 v116, v116
    v_exp_f32 v117, v117
    v_exp_f32 v118, v118
    v_exp_f32 v119, v119
    v_cvt_pk_bf16_f32 v146, v116, v117
    v_cvt_pk_bf16_f32 v147, v118, v119
    v_mfma_f32_32x32x8_bf16 v[128:143], v[42:43], v[182:183], v[128:143]
    v_exp_f32 v120, v120
    v_exp_f32 v121, v121
    v_exp_f32 v122, v122
    v_exp_f32 v123, v123
    v_cvt_pk_bf16_f32 v148, v120, v121
    v_cvt_pk_bf16_f32 v149, v122, v123
    v_mfma_f32_32x32x16_bf16 v[152:167], v[64:67], v[144:147], v[152:167]
    v_exp_f32 v124, v124
    v_exp_f32 v125, v125
    v_exp_f32 v126, v126
    v_exp_f32 v127, v127
    v_cvt_pk_bf16_f32 v150, v124, v125
    v_cvt_pk_bf16_f32 v151, v126, v127
    v_exp_f32 v128, v128
    v_exp_f32 v129, v129
    v_mfma_f32_32x32x16_bf16 v[152:167], v[68:71], v[148:151], v[152:167]
    v_exp_f32 v130, v130
    v_exp_f32 v131, v131
    v_cvt_pk_bf16_f32 v144, v128, v129
    v_cvt_pk_bf16_f32 v145, v130, v131
    v_mfma_f32_32x32x16_bf16 v[112:127], v[24:27], v[176:179], 0
    v_exp_f32 v132, v132
    v_exp_f32 v133, v133
    v_exp_f32 v134, v134
    v_exp_f32 v135, v135
    v_cvt_pk_bf16_f32 v146, v132, v133
    v_cvt_pk_bf16_f32 v147, v134, v135
    v_mfma_f32_32x32x8_bf16 v[112:127], v[44:45], v[180:181], v[112:127]
    v_exp_f32 v136, v136
    v_exp_f32 v137, v137
    v_exp_f32 v138, v138
    v_exp_f32 v139, v139
    v_cvt_pk_bf16_f32 v148, v136, v137
    v_cvt_pk_bf16_f32 v149, v138, v139
    v_mfma_f32_32x32x16_bf16 v[152:167], v[72:75], v[144:147], v[152:167]
    v_exp_f32 v140, v140
    v_exp_f32 v141, v141
    v_exp_f32 v142, v142
    v_exp_f32 v143, v143
    v_cvt_pk_bf16_f32 v150, v140, v141
    v_cvt_pk_bf16_f32 v151, v142, v143
    v_exp_f32 v112, v112
    v_exp_f32 v113, v113
    v_mfma_f32_32x32x16_bf16 v[152:167], v[76:79], v[148:151], v[152:167]
    v_exp_f32 v114, v114
    v_exp_f32 v115, v115
    v_cvt_pk_bf16_f32 v144, v112, v113
    v_cvt_pk_bf16_f32 v145, v114, v115
    v_mfma_f32_32x32x16_bf16 v[128:143], v[28:31], v[176:179], 0
    v_exp_f32 v116, v116
    v_exp_f32 v117, v117
    v_exp_f32 v118, v118
    v_exp_f32 v119, v119
    v_cvt_pk_bf16_f32 v146, v116, v117
    v_cvt_pk_bf16_f32 v147, v118, v119
    v_mfma_f32_32x32x8_bf16 v[128:143], v[44:45], v[182:183], v[128:143]
    v_exp_f32 v120, v120
    v_exp_f32 v121, v121
    v_exp_f32 v122, v122
    v_exp_f32 v123, v123
    v_cvt_pk_bf16_f32 v148, v120, v121
    v_cvt_pk_bf16_f32 v149, v122, v123
    v_mfma_f32_32x32x16_bf16 v[152:167], v[80:83], v[144:147], v[152:167]
    v_exp_f32 v124, v124
    v_exp_f32 v125, v125
    v_exp_f32 v126, v126
    v_exp_f32 v127, v127
    v_cvt_pk_bf16_f32 v150, v124, v125
    v_cvt_pk_bf16_f32 v151, v126, v127
    v_exp_f32 v128, v128
    v_exp_f32 v129, v129
    v_mfma_f32_32x32x16_bf16 v[152:167], v[84:87], v[148:151], v[152:167]
    v_exp_f32 v130, v130
    v_exp_f32 v131, v131
    v_cvt_pk_bf16_f32 v144, v128, v129
    v_cvt_pk_bf16_f32 v145, v130, v131
    v_mfma_f32_32x32x16_bf16 v[112:127], v[32:35], v[176:179], 0
    v_exp_f32 v132, v132
    v_exp_f32 v133, v133
    v_exp_f32 v134, v134
    v_exp_f32 v135, v135
    v_cvt_pk_bf16_f32 v146, v132, v133
    v_cvt_pk_bf16_f32 v147, v134, v135
    v_mfma_f32_32x32x8_bf16 v[112:127], v[46:47], v[180:181], v[112:127]
    v_exp_f32 v136, v136
    v_exp_f32 v137, v137
    v_exp_f32 v138, v138
    v_exp_f32 v139, v139
    v_cvt_pk_bf16_f32 v148, v136, v137
    v_cvt_pk_bf16_f32 v149, v138, v139
    v_mfma_f32_32x32x16_bf16 v[152:167], v[88:91], v[144:147], v[152:167]
    v_exp_f32 v140, v140
    v_exp_f32 v141, v141
    v_exp_f32 v142, v142
    v_exp_f32 v143, v143
    v_cvt_pk_bf16_f32 v150, v140, v141
    v_cvt_pk_bf16_f32 v151, v142, v143
    v_exp_f32 v112, v112
    v_exp_f32 v113, v113
    v_mfma_f32_32x32x16_bf16 v[152:167], v[92:95], v[148:151], v[152:167]
    v_exp_f32 v114, v114
    v_exp_f32 v115, v115
    v_cvt_pk_bf16_f32 v144, v112, v113
    v_cvt_pk_bf16_f32 v145, v114, v115
    v_mfma_f32_32x32x16_bf16 v[128:143], v[36:39], v[176:179], 0
    v_exp_f32 v116, v116
    v_exp_f32 v117, v117
    v_exp_f32 v118, v118
    v_exp_f32 v119, v119
    v_cvt_pk_bf16_f32 v146, v116, v117
    v_cvt_pk_bf16_f32 v147, v118, v119
    v_mfma_f32_32x32x8_bf16 v[128:143], v[46:47], v[182:183], v[128:143]
    v_exp_f32 v120, v120
    v_exp_f32 v121, v121
    v_exp_f32 v122, v122
    v_exp_f32 v123, v123
    v_cvt_pk_bf16_f32 v148, v120, v121
    v_cvt_pk_bf16_f32 v149, v122, v123
    v_mfma_f32_32x32x16_bf16 v[152:167], v[96:99], v[144:147], v[152:167]
    v_exp_f32 v124, v124
    v_exp_f32 v125, v125
    v_exp_f32 v126, v126
    v_exp_f32 v127, v127
    v_cvt_pk_bf16_f32 v150, v124, v125
    v_cvt_pk_bf16_f32 v151, v126, v127
    v_exp_f32 v128, v128
    v_exp_f32 v129, v129
    v_mfma_f32_32x32x16_bf16 v[152:167], v[100:103], v[148:151], v[152:167]
    v_exp_f32 v130, v130
    v_exp_f32 v131, v131
    v_cvt_pk_bf16_f32 v144, v128, v129
    v_cvt_pk_bf16_f32 v145, v130, v131
L_qc3:
    s_waitcnt lgkmcnt(0)
    v_readfirstlane_b32 s24, v222
    s_cmp_eq_u32 s24, 0
    s_cbranch_scc1 L_qs3
    v_mfma_f32_32x32x16_bf16 v[112:127], v[8:11], v[168:171], 0
    v_exp_f32 v132, v132
    v_exp_f32 v133, v133
    v_exp_f32 v134, v134
    v_exp_f32 v135, v135
    v_cvt_pk_bf16_f32 v146, v132, v133
    v_cvt_pk_bf16_f32 v147, v134, v135
    v_mfma_f32_32x32x8_bf16 v[112:127], v[40:41], v[172:173], v[112:127]
    v_exp_f32 v136, v136
    v_exp_f32 v137, v137
    v_exp_f32 v138, v138
    v_exp_f32 v139, v139
    v_cvt_pk_bf16_f32 v148, v136, v137
    v_cvt_pk_bf16_f32 v149, v138, v139
    v_mfma_f32_32x32x16_bf16 v[152:167], v[104:107], v[144:147], v[152:167]
    v_exp_f32 v140, v140
    v_exp_f32 v141, v141
    v_exp_f32 v142, v142
    v_exp_f32 v143, v143
    v_cvt_pk_bf16_f32 v150, v140, v141
    v_cvt_pk_bf16_f32 v151, v142, v143
    v_exp_f32 v112, v112
    v_exp_f32 v113, v113
    v_mfma_f32_32x32x16_bf16 v[152:167], v[108:111], v[148:151], v[152:167]
    v_exp_f32 v114, v114
    v_exp_f32 v115, v115
    v_cvt_pk_bf16_f32 v144, v112, v113
    v_cvt_pk_bf16_f32 v145, v114, v115
    s_xor_b32 s24, s12, 3
    s_mul_i32 s24, s24, 17920
    s_add_u32 s24, s24, 21504
    v_add_u32 v7, s24, v4
    v_add_u32 v217, s24, v5
    v_mfma_f32_32x32x16_bf16 v[128:143], v[12:15], v[168:171], 0
    v_exp_f32 v116, v116
    v_exp_f32 v117, v117
    v_exp_f32 v118, v118
    v_exp_f32 v119, v119
    v_cvt_pk_bf16_f32 v146, v116, v117
    v_cvt_pk_bf16_f32 v147, v118, v119
    v_mfma_f32_32x32x8_bf16 v[128:143], v[40:41], v[174:175], v[128:143]
    v_exp_f32 v120, v120
    ds_write_b128 v7, v[152:155]
    v_exp_f32 v121, v121
    ds_write_b128 v7, v[156:159] offset:1024
    v_exp_f32 v122, v122
    ds_write_b64 v217, v[160:161] offset:2048
    v_exp_f32 v123, v123
    v_cvt_pk_bf16_f32 v148, v120, v121
    v_cvt_pk_bf16_f32 v149, v122, v123
    v_mfma_f32_32x32x16_bf16 v[152:167], v[48:51], v[144:147], 0
    v_exp_f32 v124, v124
    v_exp_f32 v125, v125
    v_exp_f32 v126, v126
    v_exp_f32 v127, v127
    v_cvt_pk_bf16_f32 v150, v124, v125
    v_cvt_pk_bf16_f32 v151, v126, v127
    v_exp_f32 v128, v128
    v_exp_f32 v129, v129
    v_mfma_f32_32x32x16_bf16 v[152:167], v[52:55], v[148:151], v[152:167]
    v_exp_f32 v130, v130
    v_exp_f32 v131, v131
    v_cvt_pk_bf16_f32 v144, v128, v129
    v_cvt_pk_bf16_f32 v145, v130, v131
    v_mfma_f32_32x32x16_bf16 v[112:127], v[16:19], v[168:171], 0
    v_exp_f32 v132, v132
    v_exp_f32 v133, v133
    v_exp_f32 v134, v134
    v_exp_f32 v135, v135
    v_cvt_pk_bf16_f32 v146, v132, v133
    v_cvt_pk_bf16_f32 v147, v134, v135
    v_mfma_f32_32x32x8_bf16 v[112:127], v[42:43], v[172:173], v[112:127]
    v_exp_f32 v136, v136
    v_exp_f32 v137, v137
    v_exp_f32 v138, v138
    v_exp_f32 v139, v139
    v_cvt_pk_bf16_f32 v148, v136, v137
    v_cvt_pk_bf16_f32 v149, v138, v139
    v_mfma_f32_32x32x16_bf16 v[152:167], v[56:59], v[144:147], v[152:167]
    v_exp_f32 v140, v140
    v_exp_f32 v141, v141
    v_exp_f32 v142, v142
    v_exp_f32 v143, v143
    v_cvt_pk_bf16_f32 v150, v140, v141
    v_cvt_pk_bf16_f32 v151, v142, v143
    v_xor_b32 v6, 2048, v6
    v_xor_b32 v221, 4, v221
    ds_read_b32 v222, v221
    ds_read_b128 v[176:179], v6 offset:0
    ds_read_b128 v[180:183], v6 offset:1024
    v_exp_f32 v112, v112
    v_exp_f32 v113, v113
    v_mfma_f32_32x32x16_bf16 v[152:167], v[60:63], v[148:151], v[152:167]
    v_exp_f32 v114, v114
    v_exp_f32 v115, v115
    v_cvt_pk_bf16_f32 v144, v112, v113
    v_cvt_pk_bf16_f32 v145, v114, v115
    v_mfma_f32_32x32x16_bf16 v[128:143], v[20:23], v[168:171], 0
    v_exp_f32 v116, v116
    v_exp_f32 v117, v117
    v_exp_f32 v118, v118
    v_exp_f32 v119, v119
    v_cvt_pk_bf16_f32 v146, v116, v117
    v_cvt_pk_bf16_f32 v147, v118, v119
    v_mfma_f32_32x32x8_bf16 v[128:143], v[42:43], v[174:175], v[128:143]
    v_exp_f32 v120, v120
    v_exp_f32 v121, v121
    v_exp_f32 v122, v122
    v_exp_f32 v123, v123
    v_cvt_pk_bf16_f32 v148, v120, v121
    v_cvt_pk_bf16_f32 v149, v122, v123
    v_mfma_f32_32x32x16_bf16 v[152:167], v[64:67], v[144:147], v[152:167]
    v_exp_f32 v124, v124
    v_exp_f32 v125, v125
    v_exp_f32 v126, v126
    v_exp_f32 v127, v127
    v_cvt_pk_bf16_f32 v150, v124, v125
    v_cvt_pk_bf16_f32 v151, v126, v127
    v_exp_f32 v128, v128
    v_exp_f32 v129, v129
    v_mfma_f32_32x32x16_bf16 v[152:167], v[68:71], v[148:151], v[152:167]
    v_exp_f32 v130, v130
    v_exp_f32 v131, v131
    v_cvt_pk_bf16_f32 v144, v128, v129
    v_cvt_pk_bf16_f32 v145, v130, v131
    v_mfma_f32_32x32x16_bf16 v[112:127], v[24:27], v[168:171], 0
    v_exp_f32 v132, v132
    v_exp_f32 v133, v133
    v_exp_f32 v134, v134
    v_exp_f32 v135, v135
    v_cvt_pk_bf16_f32 v146, v132, v133
    v_cvt_pk_bf16_f32 v147, v134, v135
    v_mfma_f32_32x32x8_bf16 v[112:127], v[44:45], v[172:173], v[112:127]
    v_exp_f32 v136, v136
    v_exp_f32 v137, v137
    v_exp_f32 v138, v138
    v_exp_f32 v139, v139
    v_cvt_pk_bf16_f32 v148, v136, v137
    v_cvt_pk_bf16_f32 v149, v138, v139
    v_mfma_f32_32x32x16_bf16 v[152:167], v[72:75], v[144:147], v[152:167]
    v_exp_f32 v140, v140
    v_exp_f32 v141, v141
    v_exp_f32 v142, v142
    v_exp_f32 v143, v143
    v_cvt_pk_bf16_f32 v150, v140, v141
    v_cvt_pk_bf16_f32 v151, v142, v143
    v_exp_f32 v112, v112
    v_exp_f32 v113, v113
    v_mfma_f32_32x32x16_bf16 v[152:167], v[76:79], v[148:151], v[152:167]
    v_exp_f32 v114, v114
    v_exp_f32 v115, v115
    v_cvt_pk_bf16_f32 v144, v112, v113
    v_cvt_pk_bf16_f32 v145, v114, v115
    v_mfma_f32_32x32x16_bf16 v[128:143], v[28:31], v[168:171], 0
    v_exp_f32 v116, v116
    v_exp_f32 v117, v117
    v_exp_f32 v118, v118
    v_exp_f32 v119, v119
    v_cvt_pk_bf16_f32 v146, v116, v117
    v_cvt_pk_bf16_f32 v147, v118, v119
    v_mfma_f32_32x32x8_bf16 v[128:143], v[44:45], v[174:175], v[128:143]
    v_exp_f32 v120, v120
    v_exp_f32 v121, v121
    v_exp_f32 v122, v122
    v_exp_f32 v123, v123
    v_cvt_pk_bf16_f32 v148, v120, v121
    v_cvt_pk_bf16_f32 v149, v122, v123
    v_mfma_f32_32x32x16_bf16 v[152:167], v[80:83], v[144:147], v[152:167]
    v_exp_f32 v124, v124
    v_exp_f32 v125, v125
    v_exp_f32 v126, v126
    v_exp_f32 v127, v127
    v_cvt_pk_bf16_f32 v150, v124, v125
    v_cvt_pk_bf16_f32 v151, v126, v127
    v_exp_f32 v128, v128
    v_exp_f32 v129, v129
    v_mfma_f32_32x32x16_bf16 v[152:167], v[84:87], v[148:151], v[152:167]
    v_exp_f32 v130, v130
    v_exp_f32 v131, v131
    v_cvt_pk_bf16_f32 v144, v128, v129
    v_cvt_pk_bf16_f32 v145, v130, v131
    v_mfma_f32_32x32x16_bf16 v[112:127], v[32:35], v[168:171], 0
    v_exp_f32 v132, v132
    v_exp_f32 v133, v133
    v_exp_f32 v134, v134
    v_exp_f32 v135, v135
    v_cvt_pk_bf16_f32 v146, v132, v133
    v_cvt_pk_bf16_f32 v147, v134, v135
    v_mfma_f32_32x32x8_bf16 v[112:127], v[46:47], v[172:173], v[112:127]
    v_exp_f32 v136, v136
    v_exp_f32 v137, v137
    v_exp_f32 v138, v138
    v_exp_f32 v139, v139
    v_cvt_pk_bf16_f32 v148, v136, v137
    v_cvt_pk_bf16_f32 v149, v138, v139
    v_mfma_f32_32x32x16_bf16 v[152:167], v[88:91], v[144:147], v[152:167]
    v_exp_f32 v140, v140
    v_exp_f32 v141, v141
    v_exp_f32 v142, v142
    v_exp_f32 v143, v143
    v_cvt_pk_bf16_f32 v150, v140, v141
    v_cvt_pk_bf16_f32 v151, v142, v143
    v_exp_f32 v112, v112
    v_exp_f32 v113, v113
    v_mfma_f32_32x32x16_bf16 v[152:167], v[92:95], v[148:151], v[152:167]
    v_exp_f32 v114, v114
    v_exp_f32 v115, v115
    v_cvt_pk_bf16_f32 v144, v112, v113
    v_cvt_pk_bf16_f32 v145, v114, v115
    v_mfma_f32_32x32x16_bf16 v[128:143], v[36:39], v[168:171], 0
    v_exp_f32 v116, v116
    v_exp_f32 v117, v117
    v_exp_f32 v118, v118
    v_exp_f32 v119, v119
    v_cvt_pk_bf16_f32 v146, v116, v117
    v_cvt_pk_bf16_f32 v147, v118, v119
    v_mfma_f32_32x32x8_bf16 v[128:143], v[46:47], v[174:175], v[128:143]
    v_exp_f32 v120, v120
    v_exp_f32 v121, v121
    v_exp_f32 v122, v122
    v_exp_f32 v123, v123
    v_cvt_pk_bf16_f32 v148, v120, v121
    v_cvt_pk_bf16_f32 v149, v122, v123
    v_mfma_f32_32x32x16_bf16 v[152:167], v[96:99], v[144:147], v[152:167]
    v_exp_f32 v124, v124
    v_exp_f32 v125, v125
    v_exp_f32 v126, v126
    v_exp_f32 v127, v127
    v_cvt_pk_bf16_f32 v150, v124, v125
    v_cvt_pk_bf16_f32 v151, v126, v127
    v_exp_f32 v128, v128
    v_exp_f32 v129, v129
    v_mfma_f32_32x32x16_bf16 v[152:167], v[100:103], v[148:151], v[152:167]
    v_exp_f32 v130, v130
    v_exp_f32 v131, v131
    v_cvt_pk_bf16_f32 v144, v128, v129
    v_cvt_pk_bf16_f32 v145, v130, v131
L_qc4:
    s_waitcnt lgkmcnt(0)
    v_readfirstlane_b32 s24, v222
    s_cmp_eq_u32 s24, 0
    s_cbranch_scc1 L_qs4
    v_mfma_f32_32x32x16_bf16 v[112:127], v[8:11], v[176:179], 0
    v_exp_f32 v132, v132
    v_exp_f32 v133, v133
    v_exp_f32 v134, v134
    v_exp_f32 v135, v135
    v_cvt_pk_bf16_f32 v146, v132, v133
    v_cvt_pk_bf16_f32 v147, v134, v135
    v_mfma_f32_32x32x8_bf16 v[112:127], v[40:41], v[180:181], v[112:127]
    v_exp_f32 v136, v136
    v_exp_f32 v137, v137
    v_exp_f32 v138, v138
    v_exp_f32 v139, v139
    v_cvt_pk_bf16_f32 v148, v136, v137
    v_cvt_pk_bf16_f32 v149, v138, v139
    v_mfma_f32_32x32x16_bf16 v[152:167], v[104:107], v[144:147], v[152:167]
    v_exp_f32 v140, v140
    v_exp_f32 v141, v141
    v_exp_f32 v142, v142
    v_exp_f32 v143, v143
    v_cvt_pk_bf16_f32 v150, v140, v141
    v_cvt_pk_bf16_f32 v151, v142, v143
    s_branch L_step5
L_job12:
    v_exp_f32 v112, v112
    v_exp_f32 v113, v113
    v_mfma_f32_32x32x16_bf16 v[152:167], v[108:111], v[148:151], v[152:167]
    v_exp_f32 v114, v114
    v_exp_f32 v115, v115
    v_cvt_pk_bf16_f32 v144, v112, v113
    v_cvt_pk_bf16_f32 v145, v114, v115
    s_xor_b32 s24, s12, 1
    s_mul_i32 s24, s24, 17920
    s_add_u32 s24, s24, 16384
    v_add_u32 v7, s24, v4
    v_add_u32 v217, s24, v5
    v_mfma_f32_32x32x16_bf16 v[128:143], v[12:15], v[168:171], 0
    v_exp_f32 v116, v116
    v_exp_f32 v117, v117
    v_exp_f32 v118, v118
    v_exp_f32 v119, v119
    v_cvt_pk_bf16_f32 v146, v116, v117
    v_cvt_pk_bf16_f32 v147, v118, v119
    v_mfma_f32_32x32x8_bf16 v[128:143], v[40:41], v[174:175], v[128:143]
    v_exp_f32 v120, v120
    ds_write_b128 v7, v[152:155]
    v_exp_f32 v121, v121
    ds_write_b128 v7, v[156:159] offset:1024
    v_exp_f32 v122, v122
    ds_write_b64 v217, v[160:161] offset:2048
    v_exp_f32 v123, v123
    v_cvt_pk_bf16_f32 v148, v120, v121
    v_cvt_pk_bf16_f32 v149, v122, v123
    v_mfma_f32_32x32x16_bf16 v[152:167], v[48:51], v[144:147], 0
    v_exp_f32 v124, v124
    v_exp_f32 v125, v125
    v_exp_f32 v126, v126
    v_exp_f32 v127, v127
    v_cvt_pk_bf16_f32 v150, v124, v125
    v_cvt_pk_bf16_f32 v151, v126, v127
    s_cmp_lg_u32 s12, 0
    s_cbranch_scc1 L_sl4_x
    s_mov_b32 s24, 11599872
    buffer_load_dword v240, v4, s[8:11], s24 offen offset:4 sc1
    buffer_load_dword v241, v4, s[8:11], s24 offen offset:1028 sc1
    buffer_load_dword v242, v4, s[8:11], s24 offen offset:2052 sc1
    buffer_load_dword v243, v4, s[8:11], s24 offen offset:3076 sc1
L_sl4_x:
    v_exp_f32 v128, v128
    v_exp_f32 v129, v129
    v_mfma_f32_32x32x16_bf16 v[152:167], v[52:55], v[148:151], v[152:167]
    v_exp_f32 v130, v130
    v_exp_f32 v131, v131
    v_cvt_pk_bf16_f32 v144, v128, v129
    v_cvt_pk_bf16_f32 v145, v130, v131
    v_mfma_f32_32x32x16_bf16 v[112:127], v[16:19], v[168:171], 0
    v_exp_f32 v132, v132
    v_exp_f32 v133, v133
    v_exp_f32 v134, v134
    v_exp_f32 v135, v135
    v_cvt_pk_bf16_f32 v146, v132, v133
    v_cvt_pk_bf16_f32 v147, v134, v135
    v_mfma_f32_32x32x8_bf16 v[112:127], v[42:43], v[172:173], v[112:127]
    v_exp_f32 v136, v136
    v_exp_f32 v137, v137
    v_exp_f32 v138, v138
    v_exp_f32 v139, v139
    v_cvt_pk_bf16_f32 v148, v136, v137
    v_cvt_pk_bf16_f32 v149, v138, v139
    v_mfma_f32_32x32x16_bf16 v[152:167], v[56:59], v[144:147], v[152:167]
    v_exp_f32 v140, v140
    v_exp_f32 v141, v141
    v_exp_f32 v142, v142
    v_exp_f32 v143, v143
    v_cvt_pk_bf16_f32 v150, v140, v141
    v_cvt_pk_bf16_f32 v151, v142, v143
    v_xor_b32 v6, 2048, v6
    v_xor_b32 v221, 4, v221
    ds_read_b32 v222, v221
    ds_read_b128 v[176:179], v6 offset:0
    ds_read_b128 v[180:183], v6 offset:1024
    v_exp_f32 v112, v112
    v_exp_f32 v113, v113
    v_mfma_f32_32x32x16_bf16 v[152:167], v[60:63], v[148:151], v[152:167]
    v_exp_f32 v114, v114
    v_exp_f32 v115, v115
    v_cvt_pk_bf16_f32 v144, v112, v113
    v_cvt_pk_bf16_f32 v145, v114, v115
    v_mfma_f32_32x32x16_bf16 v[128:143], v[20:23], v[168:171], 0
    v_exp_f32 v116, v116
    v_exp_f32 v117, v117
    v_exp_f32 v118, v118
    v_exp_f32 v119, v119
    v_cvt_pk_bf16_f32 v146, v116, v117
    v_cvt_pk_bf16_f32 v147, v118, v119
    v_mfma_f32_32x32x8_bf16 v[128:143], v[42:43], v[174:175], v[128:143]
    v_exp_f32 v120, v120
    v_exp_f32 v121, v121
    v_exp_f32 v122, v122
    v_exp_f32 v123, v123
    v_cvt_pk_bf16_f32 v148, v120, v121
    v_cvt_pk_bf16_f32 v149, v122, v123
    v_mfma_f32_32x32x16_bf16 v[152:167], v[64:67], v[144:147], v[152:167]
    v_exp_f32 v124, v124
    v_exp_f32 v125, v125
    v_exp_f32 v126, v126
    v_exp_f32 v127, v127
    v_cvt_pk_bf16_f32 v150, v124, v125
    v_cvt_pk_bf16_f32 v151, v126, v127
    s_mov_b32 s21, 40000
    v_mov_b32 v244, 160852
    s_cmp_lg_u32 s12, 0
    s_cbranch_scc1 L_fa_w
L_fa_c:
    s_waitcnt vmcnt(0)
    v_xor_b32 v240, v240, v0
    v_xor_b32 v241, v241, v0
    v_xor_b32 v242, v242, v0
    v_xor_b32 v243, v243, v0
    v_or3_b32 v240, v240, v241, v242
    v_or_b32 v240, v240, v243
    v_cmp_ne_u32 vcc, 0, v240
    v_mov_b32 v245, 1
    s_cbranch_vccnz L_fa_s
L_fa_p:
    ds_write_b32 v244, v245
    s_branch L_fa_ok
L_fa_w:
    ds_read_b32 v245, v244
    s_waitcnt lgkmcnt(0)
    v_readfirstlane_b32 s24, v245
    s_cmp_lg_u32 s24, 0
    s_cbranch_scc1 L_fa_ok
    s_sleep 4
    s_branch L_fa_w
L_fa_ok:
    buffer_load_dwordx4 v[200:203], v4, s[8:11], s53 offen offset:0 sc1
    buffer_load_dwordx4 v[204:207], v4, s[8:11], s54 offen offset:0 sc1
    buffer_load_dwordx4 v[208:211], v4, s[8:11], s53 offen offset:1024 sc1
    buffer_load_dwordx4 v[212:215], v4, s[8:11], s54 offen offset:1024 sc1
    buffer_load_dwordx4 v[240:243], v4, s[8:11], s53 offen offset:2048 sc1
    buffer_load_dwordx4 v[244:247], v4, s[8:11], s54 offen offset:2048 sc1
    buffer_load_dwordx4 v[248:251], v4, s[8:11], s53 offen offset:3072 sc1
    buffer_load_dwordx4 v[252:255], v4, s[8:11], s54 offen offset:3072 sc1
    s_add_u32 s53, s53, 4096
    s_add_u32 s54, s54, 4096
    v_exp_f32 v128, v128
    v_exp_f32 v129, v129
    v_mfma_f32_32x32x16_bf16 v[152:167], v[68:71], v[148:151], v[152:167]
    v_exp_f32 v130, v130
    v_exp_f32 v131, v131
    v_cvt_pk_bf16_f32 v144, v128, v129
    v_cvt_pk_bf16_f32 v145, v130, v131
    v_mfma_f32_32x32x16_bf16 v[112:127], v[24:27], v[168:171], 0
    v_exp_f32 v132, v132
    v_exp_f32 v133, v133
    v_exp_f32 v134, v134
    v_exp_f32 v135, v135
    v_cvt_pk_bf16_f32 v146, v132, v133
    v_cvt_pk_bf16_f32 v147, v134, v135
    v_mfma_f32_32x32x8_bf16 v[112:127], v[44:45], v[172:173], v[112:127]
    v_exp_f32 v136, v136
    v_exp_f32 v137, v137
    v_exp_f32 v138, v138
    v_exp_f32 v139, v139
    v_cvt_pk_bf16_f32 v148, v136, v137
    v_cvt_pk_bf16_f32 v149, v138, v139
    v_mfma_f32_32x32x16_bf16 v[152:167], v[72:75], v[144:147], v[152:167]
    v_exp_f32 v140, v140
    v_exp_f32 v141, v141
    v_exp_f32 v142, v142
    v_exp_f32 v143, v143
    v_cvt_pk_bf16_f32 v150, v140, v141
    v_cvt_pk_bf16_f32 v151, v142, v143
    v_exp_f32 v112, v112
    v_exp_f32 v113, v113
    v_mfma_f32_32x32x16_bf16 v[152:167], v[76:79], v[148:151], v[152:167]
    v_exp_f32 v114, v114
    v_exp_f32 v115, v115
    v_cvt_pk_bf16_f32 v144, v112, v113
    v_cvt_pk_bf16_f32 v145, v114, v115
    v_mfma_f32_32x32x16_bf16 v[128:143], v[28:31], v[168:171], 0
    v_exp_f32 v116, v116
    v_exp_f32 v117, v117
    v_exp_f32 v118, v118
    v_exp_f32 v119, v119
    v_cvt_pk_bf16_f32 v146, v116, v117
    v_cvt_pk_bf16_f32 v147, v118, v119
    v_mfma_f32_32x32x8_bf16 v[128:143], v[44:45], v[174:175], v[128:143]
    v_exp_f32 v120, v120
    v_exp_f32 v121, v121
    v_exp_f32 v122, v122
    v_exp_f32 v123, v123
    v_cvt_pk_bf16_f32 v148, v120, v121
    v_cvt_pk_bf16_f32 v149, v122, v123
    v_mfma_f32_32x32x16_bf16 v[152:167], v[80:83], v[144:147], v[152:167]
    v_exp_f32 v124, v124
    v_exp_f32 v125, v125
    v_exp_f32 v126, v126
    v_exp_f32 v127, v127
    v_cvt_pk_bf16_f32 v150, v124, v125
    v_cvt_pk_bf16_f32 v151, v126, v127
    v_exp_f32 v128, v128
    v_exp_f32 v129, v129
    v_mfma_f32_32x32x16_bf16 v[152:167], v[84:87], v[148:151], v[152:167]
    v_exp_f32 v130, v130
    v_exp_f32 v131, v131
    v_cvt_pk_bf16_f32 v144, v128, v129
    v_cvt_pk_bf16_f32 v145, v130, v131
    v_mfma_f32_32x32x16_bf16 v[112:127], v[32:35], v[168:171], 0
    v_exp_f32 v132, v132
    v_exp_f32 v133, v133
    v_exp_f32 v134, v134
    v_exp_f32 v135, v135
    v_cvt_pk_bf16_f32 v146, v132, v133
    v_cvt_pk_bf16_f32 v147, v134, v135
    v_mfma_f32_32x32x8_bf16 v[112:127], v[46:47], v[172:173], v[112:127]
    v_exp_f32 v136, v136
    v_exp_f32 v137, v137
    v_exp_f32 v138, v138
    v_exp_f32 v139, v139
    v_cvt_pk_bf16_f32 v148, v136, v137
    v_cvt_pk_bf16_f32 v149, v138, v139
    v_mfma_f32_32x32x16_bf16 v[152:167], v[88:91], v[144:147], v[152:167]
    v_exp_f32 v140, v140
    v_exp_f32 v141, v141
    v_exp_f32 v142, v142
    v_exp_f32 v143, v143
    v_cvt_pk_bf16_f32 v150, v140, v141
    v_cvt_pk_bf16_f32 v151, v142, v143
    s_waitcnt vmcnt(6)
    v_mfma_f32_32x32x16_bf16 v[224:239], v[200:203], v[204:207], 0
    buffer_load_dwordx4 v[200:203], v4, s[8:11], s53 offen offset:0 sc1
    buffer_load_dwordx4 v[204:207], v4, s[8:11], s54 offen offset:0 sc1
    v_exp_f32 v112, v112
    v_exp_f32 v113, v113
    v_mfma_f32_32x32x16_bf16 v[152:167], v[92:95], v[148:151], v[152:167]
    v_exp_f32 v114, v114
    v_exp_f32 v115, v115
    v_cvt_pk_bf16_f32 v144, v112, v113
    v_cvt_pk_bf16_f32 v145, v114, v115
    v_mfma_f32_32x32x16_bf16 v[128:143], v[36:39], v[168:171], 0
    v_exp_f32 v116, v116
    v_exp_f32 v117, v117
    v_exp_f32 v118, v118
    v_exp_f32 v119, v119
    v_cvt_pk_bf16_f32 v146, v116, v117
    v_cvt_pk_bf16_f32 v147, v118, v119
    v_mfma_f32_32x32x8_bf16 v[128:143], v[46:47], v[174:175], v[128:143]
    v_exp_f32 v120, v120
    v_exp_f32 v121, v121
    v_exp_f32 v122, v122
    v_exp_f32 v123, v123
    v_cvt_pk_bf16_f32 v148, v120, v121
    v_cvt_pk_bf16_f32 v149, v122, v123
    v_mfma_f32_32x32x16_bf16 v[152:167], v[96:99], v[144:147], v[152:167]
    v_exp_f32 v124, v124
    v_exp_f32 v125, v125
    v_exp_f32 v126, v126
    v_exp_f32 v127, v127
    v_cvt_pk_bf16_f32 v150, v124, v125
    v_cvt_pk_bf16_f32 v151, v126, v127
    s_waitcnt vmcnt(6)
    v_mfma_f32_32x32x16_bf16 v[224:239], v[208:211], v[212:215], v[224:239]
    buffer_load_dwordx4 v[208:211], v4, s[8:11], s53 offen offset:1024 sc1
    buffer_load_dwordx4 v[212:215], v4, s[8:11], s54 offen offset:1024 sc1
    v_exp_f32 v128, v128
    v_exp_f32 v129, v129
    v_mfma_f32_32x32x16_bf16 v[152:167], v[100:103], v[148:151], v[152:167]
    v_exp_f32 v130, v130
    v_exp_f32 v131, v131
    v_cvt_pk_bf16_f32 v144, v128, v129
    v_cvt_pk_bf16_f32 v145, v130, v131
L_qc5:
    s_waitcnt lgkmcnt(0)
    v_readfirstlane_b32 s24, v222
    s_cmp_eq_u32 s24, 0
    s_cbranch_scc1 L_qs5
    v_mfma_f32_32x32x16_bf16 v[112:127], v[8:11], v[176:179], 0
    v_exp_f32 v132, v132
    v_exp_f32 v133, v133
    v_exp_f32 v134, v134
    v_exp_f32 v135, v135
    v_cvt_pk_bf16_f32 v146, v132, v133
    v_cvt_pk_bf16_f32 v147, v134, v135
    v_mfma_f32_32x32x8_bf16 v[112:127], v[40:41], v[180:181], v[112:127]
    v_exp_f32 v136, v136
    v_exp_f32 v137, v137
    v_exp_f32 v138, v138
    v_exp_f32 v139, v139
    v_cvt_pk_bf16_f32 v148, v136, v137
    v_cvt_pk_bf16_f32 v149, v138, v139
    v_mfma_f32_32x32x16_bf16 v[152:167], v[104:107], v[144:147], v[152:167]
    v_exp_f32 v140, v140
    v_exp_f32 v141, v141
    v_exp_f32 v142, v142
    v_exp_f32 v143, v143
    v_cvt_pk_bf16_f32 v150, v140, v141
    v_cvt_pk_bf16_f32 v151, v142, v143
    s_waitcnt vmcnt(6)
    v_mfma_f32_32x32x16_bf16 v[224:239], v[240:243], v[244:247], v[224:239]
    buffer_load_dwordx4 v[240:243], v4, s[8:11], s53 offen offset:2048 sc1
    buffer_load_dwordx4 v[244:247], v4, s[8:11], s54 offen offset:2048 sc1
    v_exp_f32 v112, v112
    v_exp_f32 v113, v113
    v_mfma_f32_32x32x16_bf16 v[152:167], v[108:111], v[148:151], v[152:167]
    v_exp_f32 v114, v114
    v_exp_f32 v115, v115
    v_cvt_pk_bf16_f32 v144, v112, v113
    v_cvt_pk_bf16_f32 v145, v114, v115
    s_xor_b32 s24, s12, 2
    s_mul_i32 s24, s24, 17920
    s_add_u32 s24, s24, 18944
    v_add_u32 v7, s24, v4
    v_add_u32 v217, s24, v5
    v_mfma_f32_32x32x16_bf16 v[128:143], v[12:15], v[176:179], 0
    v_exp_f32 v116, v116
    v_exp_f32 v117, v117
    v_exp_f32 v118, v118
    v_exp_f32 v119, v119
    v_cvt_pk_bf16_f32 v146, v116, v117
    v_cvt_pk_bf16_f32 v147, v118, v119
    v_mfma_f32_32x32x8_bf16 v[128:143], v[40:41], v[182:183], v[128:143]
    v_exp_f32 v120, v120
    ds_write_b128 v7, v[152:155]
    v_exp_f32 v121, v121
    ds_write_b128 v7, v[156:159] offset:1024
    v_exp_f32 v122, v122
    ds_write_b64 v217, v[160:161] offset:2048
    v_exp_f32 v123, v123
    v_cvt_pk_bf16_f32 v148, v120, v121
    v_cvt_pk_bf16_f32 v149, v122, v123
    v_mfma_f32_32x32x16_bf16 v[152:167], v[48:51], v[144:147], 0
    v_exp_f32 v124, v124
    v_exp_f32 v125, v125
    v_exp_f32 v126, v126
    v_exp_f32 v127, v127
    v_cvt_pk_bf16_f32 v150, v124, v125
    v_cvt_pk_bf16_f32 v151, v126, v127
    s_waitcnt vmcnt(6)
    v_mfma_f32_32x32x16_bf16 v[224:239], v[248:251], v[252:255], v[224:239]
    buffer_load_dwordx4 v[248:251], v4, s[8:11], s53 offen offset:3072 sc1
    buffer_load_dwordx4 v[252:255], v4, s[8:11], s54 offen offset:3072 sc1
    s_add_u32 s53, s53, 4096
    s_add_u32 s54, s54, 4096
    v_exp_f32 v128, v128
    v_exp_f32 v129, v129
    v_mfma_f32_32x32x16_bf16 v[152:167], v[52:55], v[148:151], v[152:167]
    v_exp_f32 v130, v130
    v_exp_f32 v131, v131
    v_cvt_pk_bf16_f32 v144, v128, v129
    v_cvt_pk_bf16_f32 v145, v130, v131
    v_mfma_f32_32x32x16_bf16 v[112:127], v[16:19], v[176:179], 0
    v_exp_f32 v132, v132
    v_exp_f32 v133, v133
    v_exp_f32 v134, v134
    v_exp_f32 v135, v135
    v_cvt_pk_bf16_f32 v146, v132, v133
    v_cvt_pk_bf16_f32 v147, v134, v135
    v_mfma_f32_32x32x8_bf16 v[112:127], v[42:43], v[180:181], v[112:127]
    v_exp_f32 v136, v136
    v_exp_f32 v137, v137
    v_exp_f32 v138, v138
    v_exp_f32 v139, v139
    v_cvt_pk_bf16_f32 v148, v136, v137
    v_cvt_pk_bf16_f32 v149, v138, v139
    v_mfma_f32_32x32x16_bf16 v[152:167], v[56:59], v[144:147], v[152:167]
    v_exp_f32 v140, v140
    v_exp_f32 v141, v141
    v_exp_f32 v142, v142
    v_exp_f32 v143, v143
    v_cvt_pk_bf16_f32 v150, v140, v141
    v_cvt_pk_bf16_f32 v151, v142, v143
    s_waitcnt vmcnt(6)
    v_mfma_f32_32x32x16_bf16 v[224:239], v[200:203], v[204:207], v[224:239]
    buffer_load_dwordx4 v[200:203], v4, s[8:11], s53 offen offset:0 sc1
    buffer_load_dwordx4 v[204:207], v4, s[8:11], s54 offen offset:0 sc1
    v_xor_b32 v6, 14336, v6
    v_xor_b32 v221, 28, v221
    ds_read_b32 v222, v221
    ds_read_b128 v[168:171], v6 offset:0
    ds_read_b128 v[172:175], v6 offset:1024
    v_exp_f32 v112, v112
    v_exp_f32 v113, v113
    v_mfma_f32_32x32x16_bf16 v[152:167], v[60:63], v[148:151], v[152:167]
    v_exp_f32 v114, v114
    v_exp_f32 v115, v115
    v_cvt_pk_bf16_f32 v144, v112, v113
    v_cvt_pk_bf16_f32 v145, v114, v115
    v_mfma_f32_32x32x16_bf16 v[128:143], v[20:23], v[176:179], 0
    v_exp_f32 v116, v116
    v_exp_f32 v117, v117
    v_exp_f32 v118, v118
    v_exp_f32 v119, v119
    v_cvt_pk_bf16_f32 v146, v116, v117
    v_cvt_pk_bf16_f32 v147, v118, v119
    v_mfma_f32_32x32x8_bf16 v[128:143], v[42:43], v[182:183], v[128:143]
    v_exp_f32 v120, v120
    v_exp_f32 v121, v121
    v_exp_f32 v122, v122
    v_exp_f32 v123, v123
    v_cvt_pk_bf16_f32 v148, v120, v121
    v_cvt_pk_bf16_f32 v149, v122, v123
    v_mfma_f32_32x32x16_bf16 v[152:167], v[64:67], v[144:147], v[152:167]
    v_exp_f32 v124, v124
    v_exp_f32 v125, v125
    v_exp_f32 v126, v126
    v_exp_f32 v127, v127
    v_cvt_pk_bf16_f32 v150, v124, v125
    v_cvt_pk_bf16_f32 v151, v126, v127
    s_waitcnt vmcnt(6)
    v_mfma_f32_32x32x16_bf16 v[224:239], v[208:211], v[212:215], v[224:239]
    buffer_load_dwordx4 v[208:211], v4, s[8:11], s53 offen offset:1024 sc1
    buffer_load_dwordx4 v[212:215], v4, s[8:11], s54 offen offset:1024 sc1
    v_exp_f32 v128, v128
    v_exp_f32 v129, v129
    v_mfma_f32_32x32x16_bf16 v[152:167], v[68:71], v[148:151], v[152:167]
    v_exp_f32 v130, v130
    v_exp_f32 v131, v131
    v_cvt_pk_bf16_f32 v144, v128, v129
    v_cvt_pk_bf16_f32 v145, v130, v131
    v_mfma_f32_32x32x16_bf16 v[112:127], v[24:27], v[176:179], 0
    v_exp_f32 v132, v132
    v_exp_f32 v133, v133
    v_exp_f32 v134, v134
    v_exp_f32 v135, v135
    v_cvt_pk_bf16_f32 v146, v132, v133
    v_cvt_pk_bf16_f32 v147, v134, v135
    v_mfma_f32_32x32x8_bf16 v[112:127], v[44:45], v[180:181], v[112:127]
    v_exp_f32 v136, v136
    v_exp_f32 v137, v137
    v_exp_f32 v138, v138
    v_exp_f32 v139, v139
    v_cvt_pk_bf16_f32 v148, v136, v137
    v_cvt_pk_bf16_f32 v149, v138, v139
    v_mfma_f32_32x32x16_bf16 v[152:167], v[72:75], v[144:147], v[152:167]
    v_exp_f32 v140, v140
    v_exp_f32 v141, v141
    v_exp_f32 v142, v142
    v_exp_f32 v143, v143
    v_cvt_pk_bf16_f32 v150, v140, v141
    v_cvt_pk_bf16_f32 v151, v142, v143
    s_waitcnt vmcnt(6)
    v_mfma_f32_32x32x16_bf16 v[224:239], v[240:243], v[244:247], v[224:239]
    buffer_load_dwordx4 v[240:243], v4, s[8:11], s53 offen offset:2048 sc1
    buffer_load_dwordx4 v[244:247], v4, s[8:11], s54 offen offset:2048 sc1
    v_exp_f32 v112, v112
    v_exp_f32 v113, v113
    v_mfma_f32_32x32x16_bf16 v[152:167], v[76:79], v[148:151], v[152:167]
    v_exp_f32 v114, v114
    v_exp_f32 v115, v115
    v_cvt_pk_bf16_f32 v144, v112, v113
    v_cvt_pk_bf16_f32 v145, v114, v115
    v_mfma_f32_32x32x16_bf16 v[128:143], v[28:31], v[176:179], 0
    v_exp_f32 v116, v116
    v_exp_f32 v117, v117
    v_exp_f32 v118, v118
    v_exp_f32 v119, v119
    v_cvt_pk_bf16_f32 v146, v116, v117
    v_cvt_pk_bf16_f32 v147, v118, v119
    v_mfma_f32_32x32x8_bf16 v[128:143], v[44:45], v[182:183], v[128:143]
    v_exp_f32 v120, v120
    v_exp_f32 v121, v121
    v_exp_f32 v122, v122
    v_exp_f32 v123, v123
    v_cvt_pk_bf16_f32 v148, v120, v121
    v_cvt_pk_bf16_f32 v149, v122, v123
    v_mfma_f32_32x32x16_bf16 v[152:167], v[80:83], v[144:147], v[152:167]
    v_exp_f32 v124, v124
    v_exp_f32 v125, v125
    v_exp_f32 v126, v126
    v_exp_f32 v127, v127
    v_cvt_pk_bf16_f32 v150, v124, v125
    v_cvt_pk_bf16_f32 v151, v126, v127
    s_waitcnt vmcnt(6)
    v_mfma_f32_32x32x16_bf16 v[224:239], v[248:251], v[252:255], v[224:239]
    buffer_load_dwordx4 v[248:251], v4, s[8:11], s53 offen offset:3072 sc1
    buffer_load_dwordx4 v[252:255], v4, s[8:11], s54 offen offset:3072 sc1
    s_add_u32 s53, s53, 4096
    s_add_u32 s54, s54, 4096
    v_exp_f32 v128, v128
    v_exp_f32 v129, v129
    v_mfma_f32_32x32x16_bf16 v[152:167], v[84:87], v[148:151], v[152:167]
    v_exp_f32 v130, v130
    v_exp_f32 v131, v131
    v_cvt_pk_bf16_f32 v144, v128, v129
    v_cvt_pk_bf16_f32 v145, v130, v131
    v_mfma_f32_32x32x16_bf16 v[112:127], v[32:35], v[176:179], 0
    v_exp_f32 v132, v132
    v_exp_f32 v133, v133
    v_exp_f32 v134, v134
    v_exp_f32 v135, v135
    v_cvt_pk_bf16_f32 v146, v132, v133
    v_cvt_pk_bf16_f32 v147, v134, v135
    v_mfma_f32_32x32x8_bf16 v[112:127], v[46:47], v[180:181], v[112:127]
    v_exp_f32 v136, v136
    v_exp_f32 v137, v137
    v_exp_f32 v138, v138
    v_exp_f32 v139, v139
    v_cvt_pk_bf16_f32 v148, v136, v137
    v_cvt_pk_bf16_f32 v149, v138, v139
    v_mfma_f32_32x32x16_bf16 v[152:167], v[88:91], v[144:147], v[152:167]
    v_exp_f32 v140, v140
    v_exp_f32 v141, v141
    v_exp_f32 v142, v142
    v_exp_f32 v143, v143
    v_cvt_pk_bf16_f32 v150, v140, v141
    v_cvt_pk_bf16_f32 v151, v142, v143
    s_waitcnt vmcnt(6)
    v_mfma_f32_32x32x16_bf16 v[224:239], v[200:203], v[204:207], v[224:239]
    buffer_load_dwordx4 v[200:203], v4, s[8:11], s53 offen offset:0 sc1
    buffer_load_dwordx4 v[204:207], v4, s[8:11], s54 offen offset:0 sc1
    v_exp_f32 v112, v112
    v_exp_f32 v113, v113
    v_mfma_f32_32x32x16_bf16 v[152:167], v[92:95], v[148:151], v[152:167]
    v_exp_f32 v114, v114
    v_exp_f32 v115, v115
    v_cvt_pk_bf16_f32 v144, v112, v113
    v_cvt_pk_bf16_f32 v145, v114, v115
    v_mfma_f32_32x32x16_bf16 v[128:143], v[36:39], v[176:179], 0
    v_exp_f32 v116, v116
    v_exp_f32 v117, v117
    v_exp_f32 v118, v118
    v_exp_f32 v119, v119
    v_cvt_pk_bf16_f32 v146, v116, v117
    v_cvt_pk_bf16_f32 v147, v118, v119
    v_mfma_f32_32x32x8_bf16 v[128:143], v[46:47], v[182:183], v[128:143]
    v_exp_f32 v120, v120
    v_exp_f32 v121, v121
    v_exp_f32 v122, v122
    v_exp_f32 v123, v123
    v_cvt_pk_bf16_f32 v148, v120, v121
    v_cvt_pk_bf16_f32 v149, v122, v123
    v_mfma_f32_32x32x16_bf16 v[152:167], v[96:99], v[144:147], v[152:167]
    v_exp_f32 v124, v124
    v_exp_f32 v125, v125
    v_exp_f32 v126, v126
    v_exp_f32 v127, v127
    v_cvt_pk_bf16_f32 v150, v124, v125
    v_cvt_pk_bf16_f32 v151, v126, v127
    s_waitcnt vmcnt(6)
    v_mfma_f32_32x32x16_bf16 v[224:239], v[208:211], v[212:215], v[224:239]
    buffer_load_dwordx4 v[208:211], v4, s[8:11], s53 offen offset:1024 sc1
    buffer_load_dwordx4 v[212:215], v4, s[8:11], s54 offen offset:1024 sc1
    v_exp_f32 v128, v128
    v_exp_f32 v129, v129
    v_mfma_f32_32x32x16_bf16 v[152:167], v[100:103], v[148:151], v[152:167]
    v_exp_f32 v130, v130
    v_exp_f32 v131, v131
    v_cvt_pk_bf16_f32 v144, v128, v129
    v_cvt_pk_bf16_f32 v145, v130, v131
L_qc6:
    s_waitcnt lgkmcnt(0)
    v_readfirstlane_b32 s24, v222
    s_cmp_eq_u32 s24, 0
    s_cbranch_scc1 L_qs6
    v_mfma_f32_32x32x16_bf16 v[112:127], v[8:11], v[168:171], 0
    v_exp_f32 v132, v132
    v_exp_f32 v133, v133
    v_exp_f32 v134, v134
    v_exp_f32 v135, v135
    v_cvt_pk_bf16_f32 v146, v132, v133
    v_cvt_pk_bf16_f32 v147, v134, v135
    v_mfma_f32_32x32x8_bf16 v[112:127], v[40:41], v[172:173], v[112:127]
    v_exp_f32 v136, v136
    v_exp_f32 v137, v137
    v_exp_f32 v138, v138
    v_exp_f32 v139, v139
    v_cvt_pk_bf16_f32 v148, v136, v137
    v_cvt_pk_bf16_f32 v149, v138, v139
    v_mfma_f32_32x32x16_bf16 v[152:167], v[104:107], v[144:147], v[152:167]
    v_exp_f32 v140, v140
    v_exp_f32 v141, v141
    v_exp_f32 v142, v142
    v_exp_f32 v143, v143
    v_cvt_pk_bf16_f32 v150, v140, v141
    v_cvt_pk_bf16_f32 v151, v142, v143
    s_waitcnt vmcnt(6)
    v_mfma_f32_32x32x16_bf16 v[224:239], v[240:243], v[244:247], v[224:239]
    buffer_load_dwordx4 v[240:243], v4, s[8:11], s53 offen offset:2048 sc1
    buffer_load_dwordx4 v[244:247], v4, s[8:11], s54 offen offset:2048 sc1
    v_exp_f32 v112, v112
    v_exp_f32 v113, v113
    v_mfma_f32_32x32x16_bf16 v[152:167], v[108:111], v[148:151], v[152:167]
    v_exp_f32 v114, v114
    v_exp_f32 v115, v115
    v_cvt_pk_bf16_f32 v144, v112, v113
    v_cvt_pk_bf16_f32 v145, v114, v115
    s_xor_b32 s24, s12, 3
    s_mul_i32 s24, s24, 17920
    s_add_u32 s24, s24, 21504
    v_add_u32 v7, s24, v4
    v_add_u32 v217, s24, v5
    v_mfma_f32_32x32x16_bf16 v[128:143], v[12:15], v[168:171], 0
    v_exp_f32 v116, v116
    v_exp_f32 v117, v117
    v_exp_f32 v118, v118
    v_exp_f32 v119, v119
    v_cvt_pk_bf16_f32 v146, v116, v117
    v_cvt_pk_bf16_f32 v147, v118, v119
    v_mfma_f32_32x32x8_bf16 v[128:143], v[40:41], v[174:175], v[128:143]
    v_exp_f32 v120, v120
    ds_write_b128 v7, v[152:155]
    v_exp_f32 v121, v121
    ds_write_b128 v7, v[156:159] offset:1024
    v_exp_f32 v122, v122
    ds_write_b64 v217, v[160:161] offset:2048
    v_exp_f32 v123, v123
    v_cvt_pk_bf16_f32 v148, v120, v121
    v_cvt_pk_bf16_f32 v149, v122, v123
    v_mfma_f32_32x32x16_bf16 v[152:167], v[48:51], v[144:147], 0
    v_exp_f32 v124, v124
    v_exp_f32 v125, v125
    v_exp_f32 v126, v126
    v_exp_f32 v127, v127
    v_cvt_pk_bf16_f32 v150, v124, v125
    v_cvt_pk_bf16_f32 v151, v126, v127
    s_waitcnt vmcnt(6)
    v_mfma_f32_32x32x16_bf16 v[224:239], v[248:251], v[252:255], v[224:239]
    buffer_load_dwordx4 v[248:251], v4, s[8:11], s53 offen offset:3072 sc1
    buffer_load_dwordx4 v[252:255], v4, s[8:11], s54 offen offset:3072 sc1
    s_add_u32 s53, s53, 4096
    s_add_u32 s54, s54, 4096
    v_exp_f32 v128, v128
    v_exp_f32 v129, v129
    v_mfma_f32_32x32x16_bf16 v[152:167], v[52:55], v[148:151], v[152:167]
    v_exp_f32 v130, v130
    v_exp_f32 v131, v131
    v_cvt_pk_bf16_f32 v144, v128, v129
    v_cvt_pk_bf16_f32 v145, v130, v131
    v_mfma_f32_32x32x16_bf16 v[112:127], v[16:19], v[168:171], 0
    v_exp_f32 v132, v132
    v_exp_f32 v133, v133
    v_exp_f32 v134, v134
    v_exp_f32 v135, v135
    v_cvt_pk_bf16_f32 v146, v132, v133
    v_cvt_pk_bf16_f32 v147, v134, v135
    v_mfma_f32_32x32x8_bf16 v[112:127], v[42:43], v[172:173], v[112:127]
    v_exp_f32 v136, v136
    v_exp_f32 v137, v137
    v_exp_f32 v138, v138
    v_exp_f32 v139, v139
    v_cvt_pk_bf16_f32 v148, v136, v137
    v_cvt_pk_bf16_f32 v149, v138, v139
    v_mfma_f32_32x32x16_bf16 v[152:167], v[56:59], v[144:147], v[152:167]
    v_exp_f32 v140, v140
    v_exp_f32 v141, v141
    v_exp_f32 v142, v142
    v_exp_f32 v143, v143
    v_cvt_pk_bf16_f32 v150, v140, v141
    v_cvt_pk_bf16_f32 v151, v142, v143
    s_waitcnt vmcnt(6)
    v_mfma_f32_32x32x16_bf16 v[224:239], v[200:203], v[204:207], v[224:239]
    buffer_load_dwordx4 v[200:203], v4, s[8:11], s53 offen offset:0 sc1
    buffer_load_dwordx4 v[204:207], v4, s[8:11], s54 offen offset:0 sc1
    v_xor_b32 v6, 2048, v6
    v_xor_b32 v221, 4, v221
    ds_read_b32 v222, v221
    ds_read_b128 v[176:179], v6 offset:0
    ds_read_b128 v[180:183], v6 offset:1024
    v_exp_f32 v112, v112
    v_exp_f32 v113, v113
    v_mfma_f32_32x32x16_bf16 v[152:167], v[60:63], v[148:151], v[152:167]
    v_exp_f32 v114, v114
    v_exp_f32 v115, v115
    v_cvt_pk_bf16_f32 v144, v112, v113
    v_cvt_pk_bf16_f32 v145, v114, v115
    v_mfma_f32_32x32x16_bf16 v[128:143], v[20:23], v[168:171], 0
    v_exp_f32 v116, v116
    v_exp_f32 v117, v117
    v_exp_f32 v118, v118
    v_exp_f32 v119, v119
    v_cvt_pk_bf16_f32 v146, v116, v117
    v_cvt_pk_bf16_f32 v147, v118, v119
    v_mfma_f32_32x32x8_bf16 v[128:143], v[42:43], v[174:175], v[128:143]
    v_exp_f32 v120, v120
    v_exp_f32 v121, v121
    v_exp_f32 v122, v122
    v_exp_f32 v123, v123
    v_cvt_pk_bf16_f32 v148, v120, v121
    v_cvt_pk_bf16_f32 v149, v122, v123
    v_mfma_f32_32x32x16_bf16 v[152:167], v[64:67], v[144:147], v[152:167]
    v_exp_f32 v124, v124
    v_exp_f32 v125, v125
    v_exp_f32 v126, v126
    v_exp_f32 v127, v127
    v_cvt_pk_bf16_f32 v150, v124, v125
    v_cvt_pk_bf16_f32 v151, v126, v127
    s_waitcnt vmcnt(6)
    v_mfma_f32_32x32x16_bf16 v[224:239], v[208:211], v[212:215], v[224:239]
    buffer_load_dwordx4 v[208:211], v4, s[8:11], s53 offen offset:1024 sc1
    buffer_load_dwordx4 v[212:215], v4, s[8:11], s54 offen offset:1024 sc1
    v_exp_f32 v128, v128
    v_exp_f32 v129, v129
    v_mfma_f32_32x32x16_bf16 v[152:167], v[68:71], v[148:151], v[152:167]
    v_exp_f32 v130, v130
    v_exp_f32 v131, v131
    v_cvt_pk_bf16_f32 v144, v128, v129
    v_cvt_pk_bf16_f32 v145, v130, v131
    v_mfma_f32_32x32x16_bf16 v[112:127], v[24:27], v[168:171], 0
    v_exp_f32 v132, v132
    v_exp_f32 v133, v133
    v_exp_f32 v134, v134
    v_exp_f32 v135, v135
    v_cvt_pk_bf16_f32 v146, v132, v133
    v_cvt_pk_bf16_f32 v147, v134, v135
    v_mfma_f32_32x32x8_bf16 v[112:127], v[44:45], v[172:173], v[112:127]
    v_exp_f32 v136, v136
    v_exp_f32 v137, v137
    v_exp_f32 v138, v138
    v_exp_f32 v139, v139
    v_cvt_pk_bf16_f32 v148, v136, v137
    v_cvt_pk_bf16_f32 v149, v138, v139
    v_mfma_f32_32x32x16_bf16 v[152:167], v[72:75], v[144:147], v[152:167]
    v_exp_f32 v140, v140
    v_exp_f32 v141, v141
    v_exp_f32 v142, v142
    v_exp_f32 v143, v143
    v_cvt_pk_bf16_f32 v150, v140, v141
    v_cvt_pk_bf16_f32 v151, v142, v143
    s_waitcnt vmcnt(6)
    v_mfma_f32_32x32x16_bf16 v[224:239], v[240:243], v[244:247], v[224:239]
    v_exp_f32 v112, v112
    v_exp_f32 v113, v113
    v_mfma_f32_32x32x16_bf16 v[152:167], v[76:79], v[148:151], v[152:167]
    v_exp_f32 v114, v114
    v_exp_f32 v115, v115
    v_cvt_pk_bf16_f32 v144, v112, v113
    v_cvt_pk_bf16_f32 v145, v114, v115
    v_mfma_f32_32x32x16_bf16 v[128:143], v[28:31], v[168:171], 0
    v_exp_f32 v116, v116
    v_exp_f32 v117, v117
    v_exp_f32 v118, v118
    v_exp_f32 v119, v119
    v_cvt_pk_bf16_f32 v146, v116, v117
    v_cvt_pk_bf16_f32 v147, v118, v119
    v_mfma_f32_32x32x8_bf16 v[128:143], v[44:45], v[174:175], v[128:143]
    v_exp_f32 v120, v120
    v_exp_f32 v121, v121
    v_exp_f32 v122, v122
    v_exp_f32 v123, v123
    v_cvt_pk_bf16_f32 v148, v120, v121
    v_cvt_pk_bf16_f32 v149, v122, v123
    v_mfma_f32_32x32x16_bf16 v[152:167], v[80:83], v[144:147], v[152:167]
    v_exp_f32 v124, v124
    v_exp_f32 v125, v125
    v_exp_f32 v126, v126
    v_exp_f32 v127, v127
    v_cvt_pk_bf16_f32 v150, v124, v125
    v_cvt_pk_bf16_f32 v151, v126, v127
    s_waitcnt vmcnt(4)
    v_mfma_f32_32x32x16_bf16 v[224:239], v[248:251], v[252:255], v[224:239]
    v_exp_f32 v128, v128
    v_exp_f32 v129, v129
    v_mfma_f32_32x32x16_bf16 v[152:167], v[84:87], v[148:151], v[152:167]
    v_exp_f32 v130, v130
    v_exp_f32 v131, v131
    v_cvt_pk_bf16_f32 v144, v128, v129
    v_cvt_pk_bf16_f32 v145, v130, v131
    v_mfma_f32_32x32x16_bf16 v[112:127], v[32:35], v[168:171], 0
    v_exp_f32 v132, v132
    v_exp_f32 v133, v133
    v_exp_f32 v134, v134
    v_exp_f32 v135, v135
    v_cvt_pk_bf16_f32 v146, v132, v133
    v_cvt_pk_bf16_f32 v147, v134, v135
    v_mfma_f32_32x32x8_bf16 v[112:127], v[46:47], v[172:173], v[112:127]
    v_exp_f32 v136, v136
    v_exp_f32 v137, v137
    v_exp_f32 v138, v138
    v_exp_f32 v139, v139
    v_cvt_pk_bf16_f32 v148, v136, v137
    v_cvt_pk_bf16_f32 v149, v138, v139
    v_mfma_f32_32x32x16_bf16 v[152:167], v[88:91], v[144:147], v[152:167]
    v_exp_f32 v140, v140
    v_exp_f32 v141, v141
    v_exp_f32 v142, v142
    v_exp_f32 v143, v143
    v_cvt_pk_bf16_f32 v150, v140, v141
    v_cvt_pk_bf16_f32 v151, v142, v143
    s_waitcnt vmcnt(2)
    v_mfma_f32_32x32x16_bf16 v[224:239], v[200:203], v[204:207], v[224:239]
    v_exp_f32 v112, v112
    v_exp_f32 v113, v113
    v_mfma_f32_32x32x16_bf16 v[152:167], v[92:95], v[148:151], v[152:167]
    v_exp_f32 v114, v114
    v_exp_f32 v115, v115
    v_cvt_pk_bf16_f32 v144, v112, v113
    v_cvt_pk_bf16_f32 v145, v114, v115
    v_mfma_f32_32x32x16_bf16 v[128:143], v[36:39], v[168:171], 0
    v_exp_f32 v116, v116
    v_exp_f32 v117, v117
    v_exp_f32 v118, v118
    v_exp_f32 v119, v119
    v_cvt_pk_bf16_f32 v146, v116, v117
    v_cvt_pk_bf16_f32 v147, v118, v119
    v_mfma_f32_32x32x8_bf16 v[128:143], v[46:47], v[174:175], v[128:143]
    v_exp_f32 v120, v120
    v_exp_f32 v121, v121
    v_exp_f32 v122, v122
    v_exp_f32 v123, v123
    v_cvt_pk_bf16_f32 v148, v120, v121
    v_cvt_pk_bf16_f32 v149, v122, v123
    v_mfma_f32_32x32x16_bf16 v[152:167], v[96:99], v[144:147], v[152:167]
    v_exp_f32 v124, v124
    v_exp_f32 v125, v125
    v_exp_f32 v126, v126
    v_exp_f32 v127, v127
    v_cvt_pk_bf16_f32 v150, v124, v125
    v_cvt_pk_bf16_f32 v151, v126, v127
    s_waitcnt vmcnt(0)
    v_mfma_f32_32x32x16_bf16 v[224:239], v[208:211], v[212:215], v[224:239]
    v_exp_f32 v128, v128
    v_exp_f32 v129, v129
    v_mfma_f32_32x32x16_bf16 v[152:167], v[100:103], v[148:151], v[152:167]
    v_exp_f32 v130, v130
    v_exp_f32 v131, v131
    v_cvt_pk_bf16_f32 v144, v128, v129
    v_cvt_pk_bf16_f32 v145, v130, v131
L_qc7:
    s_waitcnt lgkmcnt(0)
    v_readfirstlane_b32 s24, v222
    s_cmp_eq_u32 s24, 0
    s_cbranch_scc1 L_qs7
    v_mfma_f32_32x32x16_bf16 v[112:127], v[8:11], v[176:179], 0
    v_exp_f32 v132, v132
    v_exp_f32 v133, v133
    v_exp_f32 v134, v134
    v_exp_f32 v135, v135
    v_cvt_pk_bf16_f32 v146, v132, v133
    v_cvt_pk_bf16_f32 v147, v134, v135
    v_mfma_f32_32x32x8_bf16 v[112:127], v[40:41], v[180:181], v[112:127]
    v_exp_f32 v136, v136
    v_exp_f32 v137, v137
    v_exp_f32 v138, v138
    v_exp_f32 v139, v139
    v_cvt_pk_bf16_f32 v148, v136, v137
    v_cvt_pk_bf16_f32 v149, v138, v139
    v_mfma_f32_32x32x16_bf16 v[152:167], v[104:107], v[144:147], v[152:167]
    v_exp_f32 v140, v140
    v_exp_f32 v141, v141
    v_exp_f32 v142, v142
    v_exp_f32 v143, v143
    v_cvt_pk_bf16_f32 v150, v140, v141
    v_cvt_pk_bf16_f32 v151, v142, v143
    v_cvt_pk_bf16_f32 v224, v224, v225
    v_cvt_pk_bf16_f32 v225, v226, v227
    v_cvt_pk_bf16_f32 v226, v228, v229
    v_cvt_pk_bf16_f32 v227, v230, v231
    v_cvt_pk_bf16_f32 v228, v232, v233
    v_cvt_pk_bf16_f32 v229, v234, v235
    v_cvt_pk_bf16_f32 v230, v236, v237
    v_cvt_pk_bf16_f32 v231, v238, v239
    buffer_store_dwordx4 v[224:227], v219, s[8:11], s55 offen sc1
    s_add_u32 s55, s55, 10240
    buffer_store_dwordx4 v[228:231], v219, s[8:11], s55 offen sc1
L_step5:
    v_exp_f32 v112, v112
    v_exp_f32 v113, v113
    v_mfma_f32_32x32x16_bf16 v[152:167], v[108:111], v[148:151], v[152:167]
    v_exp_f32 v114, v114
    v_exp_f32 v115, v115
    v_cvt_pk_bf16_f32 v144, v112, v113
    v_cvt_pk_bf16_f32 v145, v114, v115
    s_xor_b32 s24, s12, 4
    s_mul_i32 s24, s24, 17920
    s_add_u32 s24, s24, 24064
    v_add_u32 v7, s24, v4
    v_add_u32 v217, s24, v5
    v_mfma_f32_32x32x16_bf16 v[128:143], v[12:15], v[176:179], 0
    v_exp_f32 v116, v116
    v_exp_f32 v117, v117
    v_exp_f32 v118, v118
    v_exp_f32 v119, v119
    v_cvt_pk_bf16_f32 v146, v116, v117
    v_cvt_pk_bf16_f32 v147, v118, v119
    v_mfma_f32_32x32x8_bf16 v[128:143], v[40:41], v[182:183], v[128:143]
    v_exp_f32 v120, v120
    ds_write_b128 v7, v[152:155]
    v_exp_f32 v121, v121
    ds_write_b128 v7, v[156:159] offset:1024
    v_exp_f32 v122, v122
    ds_write_b64 v217, v[160:161] offset:2048
    v_exp_f32 v123, v123
    v_cvt_pk_bf16_f32 v148, v120, v121
    v_cvt_pk_bf16_f32 v149, v122, v123
    v_mfma_f32_32x32x16_bf16 v[152:167], v[48:51], v[144:147], 0
    v_exp_f32 v124, v124
    v_exp_f32 v125, v125
    v_exp_f32 v126, v126
    v_exp_f32 v127, v127
    v_cvt_pk_bf16_f32 v150, v124, v125
    v_cvt_pk_bf16_f32 v151, v126, v127
    v_exp_f32 v128, v128
    v_exp_f32 v129, v129
    v_mfma_f32_32x32x16_bf16 v[152:167], v[52:55], v[148:151], v[152:167]
    v_exp_f32 v130, v130
    v_exp_f32 v131, v131
    v_cvt_pk_bf16_f32 v144, v128, v129
    v_cvt_pk_bf16_f32 v145, v130, v131
    v_mfma_f32_32x32x16_bf16 v[112:127], v[16:19], v[176:179], 0
    v_exp_f32 v132, v132
    v_exp_f32 v133, v133
    v_exp_f32 v134, v134
    v_exp_f32 v135, v135
    v_cvt_pk_bf16_f32 v146, v132, v133
    v_cvt_pk_bf16_f32 v147, v134, v135
    v_mfma_f32_32x32x8_bf16 v[112:127], v[42:43], v[180:181], v[112:127]
    v_exp_f32 v136, v136
    v_exp_f32 v137, v137
    v_exp_f32 v138, v138
    v_exp_f32 v139, v139
    v_cvt_pk_bf16_f32 v148, v136, v137
    v_cvt_pk_bf16_f32 v149, v138, v139
    v_mfma_f32_32x32x16_bf16 v[152:167], v[56:59], v[144:147], v[152:167]
    v_exp_f32 v140, v140
    v_exp_f32 v141, v141
    v_exp_f32 v142, v142
    v_exp_f32 v143, v143
    v_cvt_pk_bf16_f32 v150, v140, v141
    v_cvt_pk_bf16_f32 v151, v142, v143
    v_xor_b32 v6, 6144, v6
    v_xor_b32 v221, 12, v221
    ds_read_b32 v222, v221
    ds_read_b128 v[168:171], v6 offset:0
    ds_read_b128 v[172:175], v6 offset:1024
    v_exp_f32 v112, v112
    v_exp_f32 v113, v113
    v_mfma_f32_32x32x16_bf16 v[152:167], v[60:63], v[148:151], v[152:167]
    v_exp_f32 v114, v114
    v_exp_f32 v115, v115
    v_cvt_pk_bf16_f32 v144, v112, v113
    v_cvt_pk_bf16_f32 v145, v114, v115
    v_mfma_f32_32x32x16_bf16 v[128:143], v[20:23], v[176:179], 0
    v_exp_f32 v116, v116
    v_exp_f32 v117, v117
    v_exp_f32 v118, v118
    v_exp_f32 v119, v119
    v_cvt_pk_bf16_f32 v146, v116, v117
    v_cvt_pk_bf16_f32 v147, v118, v119
    v_mfma_f32_32x32x8_bf16 v[128:143], v[42:43], v[182:183], v[128:143]
    v_exp_f32 v120, v120
    v_exp_f32 v121, v121
    v_exp_f32 v122, v122
    v_exp_f32 v123, v123
    v_cvt_pk_bf16_f32 v148, v120, v121
    v_cvt_pk_bf16_f32 v149, v122, v123
    v_mfma_f32_32x32x16_bf16 v[152:167], v[64:67], v[144:147], v[152:167]
    v_exp_f32 v124, v124
    v_exp_f32 v125, v125
    v_exp_f32 v126, v126
    v_exp_f32 v127, v127
    v_cvt_pk_bf16_f32 v150, v124, v125
    v_cvt_pk_bf16_f32 v151, v126, v127
    s_cmp_eq_u32 s52, 0
    s_cbranch_scc1 L_hd_x
    s_waitcnt vmcnt(0)
    v_mov_b32 v215, 1
    v_mov_b32 v214, 160832
    s_mov_b64 exec, 1
    ds_add_rtn_u32 v214, v214, v215
    s_waitcnt lgkmcnt(0)
    v_readfirstlane_b32 s24, v214
    s_cmp_lg_u32 s24, 3
    s_cbranch_scc1 L_jd3
    buffer_store_dword v0, v223, s[8:11], s35 offen offset:8 sc1
L_jd3:
    s_mov_b64 exec, -1
    s_mov_b32 s52, 0
L_hd_x:
    v_exp_f32 v128, v128
    v_exp_f32 v129, v129
    v_mfma_f32_32x32x16_bf16 v[152:167], v[68:71], v[148:151], v[152:167]
    v_exp_f32 v130, v130
    v_exp_f32 v131, v131
    v_cvt_pk_bf16_f32 v144, v128, v129
    v_cvt_pk_bf16_f32 v145, v130, v131
    v_mfma_f32_32x32x16_bf16 v[112:127], v[24:27], v[176:179], 0
    v_exp_f32 v132, v132
    v_exp_f32 v133, v133
    v_exp_f32 v134, v134
    v_exp_f32 v135, v135
    v_cvt_pk_bf16_f32 v146, v132, v133
    v_cvt_pk_bf16_f32 v147, v134, v135
    v_mfma_f32_32x32x8_bf16 v[112:127], v[44:45], v[180:181], v[112:127]
    v_exp_f32 v136, v136
    v_exp_f32 v137, v137
    v_exp_f32 v138, v138
    v_exp_f32 v139, v139
    v_cvt_pk_bf16_f32 v148, v136, v137
    v_cvt_pk_bf16_f32 v149, v138, v139
    v_mfma_f32_32x32x16_bf16 v[152:167], v[72:75], v[144:147], v[152:167]
    v_exp_f32 v140, v140
    v_exp_f32 v141, v141
    v_exp_f32 v142, v142
    v_exp_f32 v143, v143
    v_cvt_pk_bf16_f32 v150, v140, v141
    v_cvt_pk_bf16_f32 v151, v142, v143
    v_exp_f32 v112, v112
    v_exp_f32 v113, v113
    v_mfma_f32_32x32x16_bf16 v[152:167], v[76:79], v[148:151], v[152:167]
    v_exp_f32 v114, v114
    v_exp_f32 v115, v115
    v_cvt_pk_bf16_f32 v144, v112, v113
    v_cvt_pk_bf16_f32 v145, v114, v115
    v_mfma_f32_32x32x16_bf16 v[128:143], v[28:31], v[176:179], 0
    v_exp_f32 v116, v116
    v_exp_f32 v117, v117
    v_exp_f32 v118, v118
    v_exp_f32 v119, v119
    v_cvt_pk_bf16_f32 v146, v116, v117
    v_cvt_pk_bf16_f32 v147, v118, v119
    v_mfma_f32_32x32x8_bf16 v[128:143], v[44:45], v[182:183], v[128:143]
    v_exp_f32 v120, v120
    v_exp_f32 v121, v121
    v_exp_f32 v122, v122
    v_exp_f32 v123, v123
    v_cvt_pk_bf16_f32 v148, v120, v121
    v_cvt_pk_bf16_f32 v149, v122, v123
    v_mfma_f32_32x32x16_bf16 v[152:167], v[80:83], v[144:147], v[152:167]
    v_exp_f32 v124, v124
    v_exp_f32 v125, v125
    v_exp_f32 v126, v126
    v_exp_f32 v127, v127
    v_cvt_pk_bf16_f32 v150, v124, v125
    v_cvt_pk_bf16_f32 v151, v126, v127
    v_exp_f32 v128, v128
    v_exp_f32 v129, v129
    v_mfma_f32_32x32x16_bf16 v[152:167], v[84:87], v[148:151], v[152:167]
    v_exp_f32 v130, v130
    v_exp_f32 v131, v131
    v_cvt_pk_bf16_f32 v144, v128, v129
    v_cvt_pk_bf16_f32 v145, v130, v131
    v_mfma_f32_32x32x16_bf16 v[112:127], v[32:35], v[176:179], 0
    v_exp_f32 v132, v132
    v_exp_f32 v133, v133
    v_exp_f32 v134, v134
    v_exp_f32 v135, v135
    v_cvt_pk_bf16_f32 v146, v132, v133
    v_cvt_pk_bf16_f32 v147, v134, v135
    v_mfma_f32_32x32x8_bf16 v[112:127], v[46:47], v[180:181], v[112:127]
    v_exp_f32 v136, v136
    v_exp_f32 v137, v137
    v_exp_f32 v138, v138
    v_exp_f32 v139, v139
    v_cvt_pk_bf16_f32 v148, v136, v137
    v_cvt_pk_bf16_f32 v149, v138, v139
    v_mfma_f32_32x32x16_bf16 v[152:167], v[88:91], v[144:147], v[152:167]
    v_exp_f32 v140, v140
    v_exp_f32 v141, v141
    v_exp_f32 v142, v142
    v_exp_f32 v143, v143
    v_cvt_pk_bf16_f32 v150, v140, v141
    v_cvt_pk_bf16_f32 v151, v142, v143
    v_exp_f32 v112, v112
    v_exp_f32 v113, v113
    v_mfma_f32_32x32x16_bf16 v[152:167], v[92:95], v[148:151], v[152:167]
    v_exp_f32 v114, v114
    v_exp_f32 v115, v115
    v_cvt_pk_bf16_f32 v144, v112, v113
    v_cvt_pk_bf16_f32 v145, v114, v115
    v_mfma_f32_32x32x16_bf16 v[128:143], v[36:39], v[176:179], 0
    v_exp_f32 v116, v116
    v_exp_f32 v117, v117
    v_exp_f32 v118, v118
    v_exp_f32 v119, v119
    v_cvt_pk_bf16_f32 v146, v116, v117
    v_cvt_pk_bf16_f32 v147, v118, v119
    v_mfma_f32_32x32x8_bf16 v[128:143], v[46:47], v[182:183], v[128:143]
    v_exp_f32 v120, v120
    v_exp_f32 v121, v121
    v_exp_f32 v122, v122
    v_exp_f32 v123, v123
    v_cvt_pk_bf16_f32 v148, v120, v121
    v_cvt_pk_bf16_f32 v149, v122, v123
    v_mfma_f32_32x32x16_bf16 v[152:167], v[96:99], v[144:147], v[152:167]
    v_exp_f32 v124, v124
    v_exp_f32 v125, v125
    v_exp_f32 v126, v126
    v_exp_f32 v127, v127
    v_cvt_pk_bf16_f32 v150, v124, v125
    v_cvt_pk_bf16_f32 v151, v126, v127
    v_exp_f32 v128, v128
    v_exp_f32 v129, v129
    v_mfma_f32_32x32x16_bf16 v[152:167], v[100:103], v[148:151], v[152:167]
    v_exp_f32 v130, v130
    v_exp_f32 v131, v131
    v_cvt_pk_bf16_f32 v144, v128, v129
    v_cvt_pk_bf16_f32 v145, v130, v131
L_qc8:
    s_waitcnt lgkmcnt(0)
    v_readfirstlane_b32 s24, v222
    s_cmp_eq_u32 s24, 0
    s_cbranch_scc1 L_qs8
    v_mfma_f32_32x32x16_bf16 v[112:127], v[8:11], v[168:171], 0
    v_exp_f32 v132, v132
    v_exp_f32 v133, v133
    v_exp_f32 v134, v134
    v_exp_f32 v135, v135
    v_cvt_pk_bf16_f32 v146, v132, v133
    v_cvt_pk_bf16_f32 v147, v134, v135
    v_mfma_f32_32x32x8_bf16 v[112:127], v[40:41], v[172:173], v[112:127]
    v_exp_f32 v136, v136
    v_exp_f32 v137, v137
    v_exp_f32 v138, v138
    v_exp_f32 v139, v139
    v_cvt_pk_bf16_f32 v148, v136, v137
    v_cvt_pk_bf16_f32 v149, v138, v139
    v_mfma_f32_32x32x16_bf16 v[152:167], v[104:107], v[144:147], v[152:167]
    v_exp_f32 v140, v140
    v_exp_f32 v141, v141
    v_exp_f32 v142, v142
    v_exp_f32 v143, v143
    v_cvt_pk_bf16_f32 v150, v140, v141
    v_cvt_pk_bf16_f32 v151, v142, v143
L_at_loopx:
    s_setprio 1
    v_exp_f32 v112, v112
    v_exp_f32 v113, v113
    v_mfma_f32_32x32x16_bf16 v[152:167], v[108:111], v[148:151], v[152:167]
    v_exp_f32 v114, v114
    v_exp_f32 v115, v115
    v_cvt_pk_bf16_f32 v144, v112, v113
    v_cvt_pk_bf16_f32 v145, v114, v115
    s_xor_b32 s24, s12, 5
    s_mul_i32 s24, s24, 17920
    s_add_u32 s24, s24, 26624
    v_add_u32 v7, s24, v4
    v_add_u32 v217, s24, v5
    v_mfma_f32_32x32x16_bf16 v[128:143], v[12:15], v[168:171], 0
    v_exp_f32 v116, v116
    v_exp_f32 v117, v117
    v_exp_f32 v118, v118
    v_exp_f32 v119, v119
    v_cvt_pk_bf16_f32 v146, v116, v117
    v_cvt_pk_bf16_f32 v147, v118, v119
    v_mfma_f32_32x32x8_bf16 v[128:143], v[40:41], v[174:175], v[128:143]
    v_exp_f32 v120, v120
    ds_write_b128 v7, v[152:155]
    v_exp_f32 v121, v121
    ds_write_b128 v7, v[156:159] offset:1024
    v_exp_f32 v122, v122
    ds_write_b64 v217, v[160:161] offset:2048
    v_exp_f32 v123, v123
    v_cvt_pk_bf16_f32 v148, v120, v121
    v_cvt_pk_bf16_f32 v149, v122, v123
    v_mfma_f32_32x32x16_bf16 v[152:167], v[48:51], v[144:147], 0
    v_exp_f32 v124, v124
    v_exp_f32 v125, v125
    v_exp_f32 v126, v126
    v_exp_f32 v127, v127
    v_cvt_pk_bf16_f32 v150, v124, v125
    v_cvt_pk_bf16_f32 v151, v126, v127
    s_cmp_lg_u32 s12, 3
    s_cbranch_scc1 L_sl8_x
    s_mov_b32 s24, 11599872
    buffer_load_dword v240, v4, s[8:11], s24 offen offset:8 sc1
    buffer_load_dword v241, v4, s[8:11], s24 offen offset:1032 sc1
    buffer_load_dword v242, v4, s[8:11], s24 offen offset:2056 sc1
    buffer_load_dword v243, v4, s[8:11], s24 offen offset:3080 sc1
L_sl8_x:
    v_exp_f32 v128, v128
    v_exp_f32 v129, v129
    v_mfma_f32_32x32x16_bf16 v[152:167], v[52:55], v[148:151], v[152:167]
    v_exp_f32 v130, v130
    v_exp_f32 v131, v131
    v_cvt_pk_bf16_f32 v144, v128, v129
    v_cvt_pk_bf16_f32 v145, v130, v131
    v_mfma_f32_32x32x16_bf16 v[112:127], v[16:19], v[168:171], 0
    v_exp_f32 v132, v132
    v_exp_f32 v133, v133
    v_exp_f32 v134, v134
    v_exp_f32 v135, v135
    v_cvt_pk_bf16_f32 v146, v132, v133
    v_cvt_pk_bf16_f32 v147, v134, v135
    v_mfma_f32_32x32x8_bf16 v[112:127], v[42:43], v[172:173], v[112:127]
    v_exp_f32 v136, v136
    v_exp_f32 v137, v137
    v_exp_f32 v138, v138
    v_exp_f32 v139, v139
    v_cvt_pk_bf16_f32 v148, v136, v137
    v_cvt_pk_bf16_f32 v149, v138, v139
    v_mfma_f32_32x32x16_bf16 v[152:167], v[56:59], v[144:147], v[152:167]
    v_exp_f32 v140, v140
    v_exp_f32 v141, v141
    v_exp_f32 v142, v142
    v_exp_f32 v143, v143
    v_cvt_pk_bf16_f32 v150, v140, v141
    v_cvt_pk_bf16_f32 v151, v142, v143
    v_xor_b32 v6, 2048, v6
    v_xor_b32 v221, 4, v221
    ds_read_b32 v222, v221
    ds_read_b128 v[176:179], v6 offset:0
    ds_read_b128 v[180:183], v6 offset:1024
    v_exp_f32 v112, v112
    v_exp_f32 v113, v113
    v_mfma_f32_32x32x16_bf16 v[152:167], v[60:63], v[148:151], v[152:167]
    v_exp_f32 v114, v114
    v_exp_f32 v115, v115
    v_cvt_pk_bf16_f32 v144, v112, v113
    v_cvt_pk_bf16_f32 v145, v114, v115
    v_mfma_f32_32x32x16_bf16 v[128:143], v[20:23], v[168:171], 0
    v_exp_f32 v116, v116
    v_exp_f32 v117, v117
    v_exp_f32 v118, v118
    v_exp_f32 v119, v119
    v_cvt_pk_bf16_f32 v146, v116, v117
    v_cvt_pk_bf16_f32 v147, v118, v119
    v_mfma_f32_32x32x8_bf16 v[128:143], v[42:43], v[174:175], v[128:143]
    v_exp_f32 v120, v120
    v_exp_f32 v121, v121
    v_exp_f32 v122, v122
    v_exp_f32 v123, v123
    v_cvt_pk_bf16_f32 v148, v120, v121
    v_cvt_pk_bf16_f32 v149, v122, v123
    v_mfma_f32_32x32x16_bf16 v[152:167], v[64:67], v[144:147], v[152:167]
    v_exp_f32 v124, v124
    v_exp_f32 v125, v125
    v_exp_f32 v126, v126
    v_exp_f32 v127, v127
    v_cvt_pk_bf16_f32 v150, v124, v125
    v_cvt_pk_bf16_f32 v151, v126, v127
    s_mov_b32 s21, 40000
    v_lshrrev_b32 v219, 4, v1
    v_mul_u32_u24 v219, 2560, v219
    v_and_b32 v201, 15, v1
    v_lshl_add_u32 v219, v201, 4, v219
    s_lshl_b32 s55, s27, 10
    v_mov_b32 v244, 160856
    s_cmp_lg_u32 s12, 3
    s_cbranch_scc1 L_sf_w
L_sf_c:
    s_waitcnt vmcnt(0)
    v_xor_b32 v240, v240, v0
    v_xor_b32 v241, v241, v0
    v_xor_b32 v242, v242, v0
    v_xor_b32 v243, v243, v0
    v_or3_b32 v240, v240, v241, v242
    v_or_b32 v240, v240, v243
    v_cmp_ne_u32 vcc, 0, v240
    v_mov_b32 v245, 1
    s_cbranch_vccnz L_sf_s
L_sf_p:
    ds_write_b32 v244, v245
    s_branch L_sf_ok
L_sf_w:
    ds_read_b32 v245, v244
    s_waitcnt lgkmcnt(0)
    v_readfirstlane_b32 s24, v245
    s_cmp_lg_u32 s24, 0
    s_cbranch_scc1 L_sf_ok
    s_sleep 4
    s_branch L_sf_w
L_sf_ok:
    s_or_b32 s24, s2, s12
    s_cmp_lg_u32 s24, 0
    s_cbranch_scc1 L_ep_x
    s_mov_b32 s24, 11632640
    s_mov_b64 exec, 1
    buffer_store_dword v0, v223, s[8:11], s24 offen sc1
    s_mov_b64 exec, -1
L_ep_x:
    buffer_load_dwordx4 v[200:203], v219, s[8:11], s68 offen sc1
    buffer_load_dwordx4 v[204:207], v4, s[8:11], s69 offen offset:0 sc1
    s_add_u32 s68, s68, 10240
    buffer_load_dwordx4 v[208:211], v219, s[8:11], s68 offen sc1
    buffer_load_dwordx4 v[212:215], v4, s[8:11], s69 offen offset:1024 sc1
    s_add_u32 s68, s68, 10240
    buffer_load_dwordx4 v[240:243], v219, s[8:11], s68 offen sc1
    buffer_load_dwordx4 v[244:247], v4, s[8:11], s69 offen offset:2048 sc1
    s_add_u32 s68, s68, 10240
    buffer_load_dwordx4 v[248:251], v219, s[8:11], s68 offen sc1
    buffer_load_dwordx4 v[252:255], v4, s[8:11], s69 offen offset:3072 sc1
    s_add_u32 s68, s68, 10240
    s_add_u32 s69, s69, 4096
    v_exp_f32 v128, v128
    v_exp_f32 v129, v129
    v_mfma_f32_32x32x16_bf16 v[152:167], v[68:71], v[148:151], v[152:167]
    v_exp_f32 v130, v130
    v_exp_f32 v131, v131
    v_cvt_pk_bf16_f32 v144, v128, v129
    v_cvt_pk_bf16_f32 v145, v130, v131
    v_mfma_f32_32x32x16_bf16 v[112:127], v[24:27], v[168:171], 0
    v_exp_f32 v132, v132
    v_exp_f32 v133, v133
    v_exp_f32 v134, v134
    v_exp_f32 v135, v135
    v_cvt_pk_bf16_f32 v146, v132, v133
    v_cvt_pk_bf16_f32 v147, v134, v135
    v_mfma_f32_32x32x8_bf16 v[112:127], v[44:45], v[172:173], v[112:127]
    v_exp_f32 v136, v136
    v_exp_f32 v137, v137
    v_exp_f32 v138, v138
    v_exp_f32 v139, v139
    v_cvt_pk_bf16_f32 v148, v136, v137
    v_cvt_pk_bf16_f32 v149, v138, v139
    v_mfma_f32_32x32x16_bf16 v[152:167], v[72:75], v[144:147], v[152:167]
    v_exp_f32 v140, v140
    v_exp_f32 v141, v141
    v_exp_f32 v142, v142
    v_exp_f32 v143, v143
    v_cvt_pk_bf16_f32 v150, v140, v141
    v_cvt_pk_bf16_f32 v151, v142, v143
    v_exp_f32 v112, v112
    v_exp_f32 v113, v113
    v_mfma_f32_32x32x16_bf16 v[152:167], v[76:79], v[148:151], v[152:167]
    v_exp_f32 v114, v114
    v_exp_f32 v115, v115
    v_cvt_pk_bf16_f32 v144, v112, v113
    v_cvt_pk_bf16_f32 v145, v114, v115
    v_mfma_f32_32x32x16_bf16 v[128:143], v[28:31], v[168:171], 0
    v_exp_f32 v116, v116
    v_exp_f32 v117, v117
    v_exp_f32 v118, v118
    v_exp_f32 v119, v119
    v_cvt_pk_bf16_f32 v146, v116, v117
    v_cvt_pk_bf16_f32 v147, v118, v119
    v_mfma_f32_32x32x8_bf16 v[128:143], v[44:45], v[174:175], v[128:143]
    v_exp_f32 v120, v120
    v_exp_f32 v121, v121
    v_exp_f32 v122, v122
    v_exp_f32 v123, v123
    v_cvt_pk_bf16_f32 v148, v120, v121
    v_cvt_pk_bf16_f32 v149, v122, v123
    v_mfma_f32_32x32x16_bf16 v[152:167], v[80:83], v[144:147], v[152:167]
    v_exp_f32 v124, v124
    v_exp_f32 v125, v125
    v_exp_f32 v126, v126
    v_exp_f32 v127, v127
    v_cvt_pk_bf16_f32 v150, v124, v125
    v_cvt_pk_bf16_f32 v151, v126, v127
    v_exp_f32 v128, v128
    v_exp_f32 v129, v129
    v_mfma_f32_32x32x16_bf16 v[152:167], v[84:87], v[148:151], v[152:167]
    v_exp_f32 v130, v130
    v_exp_f32 v131, v131
    v_cvt_pk_bf16_f32 v144, v128, v129
    v_cvt_pk_bf16_f32 v145, v130, v131
    v_mfma_f32_32x32x16_bf16 v[112:127], v[32:35], v[168:171], 0
    v_exp_f32 v132, v132
    v_exp_f32 v133, v133
    v_exp_f32 v134, v134
    v_exp_f32 v135, v135
    v_cvt_pk_bf16_f32 v146, v132, v133
    v_cvt_pk_bf16_f32 v147, v134, v135
    v_mfma_f32_32x32x8_bf16 v[112:127], v[46:47], v[172:173], v[112:127]
    v_exp_f32 v136, v136
    v_exp_f32 v137, v137
    v_exp_f32 v138, v138
    v_exp_f32 v139, v139
    v_cvt_pk_bf16_f32 v148, v136, v137
    v_cvt_pk_bf16_f32 v149, v138, v139
    v_mfma_f32_32x32x16_bf16 v[152:167], v[88:91], v[144:147], v[152:167]
    v_exp_f32 v140, v140
    v_exp_f32 v141, v141
    v_exp_f32 v142, v142
    v_exp_f32 v143, v143
    v_cvt_pk_bf16_f32 v150, v140, v141
    v_cvt_pk_bf16_f32 v151, v142, v143
    s_waitcnt vmcnt(6)
    v_mfma_f32_32x32x16_bf16 v[224:239], v[200:203], v[204:207], 0
    buffer_load_dwordx4 v[200:203], v219, s[8:11], s68 offen sc1
    buffer_load_dwordx4 v[204:207], v4, s[8:11], s69 offen offset:0 sc1
    s_add_u32 s68, s68, 10240
    v_exp_f32 v112, v112
    v_exp_f32 v113, v113
    v_mfma_f32_32x32x16_bf16 v[152:167], v[92:95], v[148:151], v[152:167]
    v_exp_f32 v114, v114
    v_exp_f32 v115, v115
    v_cvt_pk_bf16_f32 v144, v112, v113
    v_cvt_pk_bf16_f32 v145, v114, v115
    v_mfma_f32_32x32x16_bf16 v[128:143], v[36:39], v[168:171], 0
    v_exp_f32 v116, v116
    v_exp_f32 v117, v117
    v_exp_f32 v118, v118
    v_exp_f32 v119, v119
    v_cvt_pk_bf16_f32 v146, v116, v117
    v_cvt_pk_bf16_f32 v147, v118, v119
    v_mfma_f32_32x32x8_bf16 v[128:143], v[46:47], v[174:175], v[128:143]
    v_exp_f32 v120, v120
    v_exp_f32 v121, v121
    v_exp_f32 v122, v122
    v_exp_f32 v123, v123
    v_cvt_pk_bf16_f32 v148, v120, v121
    v_cvt_pk_bf16_f32 v149, v122, v123
    v_mfma_f32_32x32x16_bf16 v[152:167], v[96:99], v[144:147], v[152:167]
    v_exp_f32 v124, v124
    v_exp_f32 v125, v125
    v_exp_f32 v126, v126
    v_exp_f32 v127, v127
    v_cvt_pk_bf16_f32 v150, v124, v125
    v_cvt_pk_bf16_f32 v151, v126, v127
    s_waitcnt vmcnt(6)
    v_mfma_f32_32x32x16_bf16 v[224:239], v[208:211], v[212:215], v[224:239]
    buffer_load_dwordx4 v[208:211], v219, s[8:11], s68 offen sc1
    buffer_load_dwordx4 v[212:215], v4, s[8:11], s69 offen offset:1024 sc1
    s_add_u32 s68, s68, 10240
    v_exp_f32 v128, v128
    v_exp_f32 v129, v129
    v_mfma_f32_32x32x16_bf16 v[152:167], v[100:103], v[148:151], v[152:167]
    v_exp_f32 v130, v130
    v_exp_f32 v131, v131
    v_cvt_pk_bf16_f32 v144, v128, v129
    v_cvt_pk_bf16_f32 v145, v130, v131
L_qc9:
    s_waitcnt lgkmcnt(0)
    v_readfirstlane_b32 s24, v222
    s_cmp_eq_u32 s24, 0
    s_cbranch_scc1 L_qs9
    v_mfma_f32_32x32x16_bf16 v[112:127], v[8:11], v[176:179], 0
    v_exp_f32 v132, v132
    v_exp_f32 v133, v133
    v_exp_f32 v134, v134
    v_exp_f32 v135, v135
    v_cvt_pk_bf16_f32 v146, v132, v133
    v_cvt_pk_bf16_f32 v147, v134, v135
    v_mfma_f32_32x32x8_bf16 v[112:127], v[40:41], v[180:181], v[112:127]
    v_exp_f32 v136, v136
    v_exp_f32 v137, v137
    v_exp_f32 v138, v138
    v_exp_f32 v139, v139
    v_cvt_pk_bf16_f32 v148, v136, v137
    v_cvt_pk_bf16_f32 v149, v138, v139
    v_mfma_f32_32x32x16_bf16 v[152:167], v[104:107], v[144:147], v[152:167]
    v_exp_f32 v140, v140
    v_exp_f32 v141, v141
    v_exp_f32 v142, v142
    v_exp_f32 v143, v143
    v_cvt_pk_bf16_f32 v150, v140, v141
    v_cvt_pk_bf16_f32 v151, v142, v143
    s_waitcnt vmcnt(6)
    v_mfma_f32_32x32x16_bf16 v[224:239], v[240:243], v[244:247], v[224:239]
    buffer_load_dwordx4 v[240:243], v219, s[8:11], s68 offen sc1
    buffer_load_dwordx4 v[244:247], v4, s[8:11], s69 offen offset:2048 sc1
    s_add_u32 s68, s68, 10240
    v_exp_f32 v112, v112
    v_exp_f32 v113, v113
    v_mfma_f32_32x32x16_bf16 v[152:167], v[108:111], v[148:151], v[152:167]
    v_exp_f32 v114, v114
    v_exp_f32 v115, v115
    v_cvt_pk_bf16_f32 v144, v112, v113
    v_cvt_pk_bf16_f32 v145, v114, v115
    s_xor_b32 s24, s12, 6
    s_mul_i32 s24, s24, 17920
    s_add_u32 s24, s24, 29184
    v_add_u32 v7, s24, v4
    v_add_u32 v217, s24, v5
    v_mfma_f32_32x32x16_bf16 v[128:143], v[12:15], v[176:179], 0
    v_exp_f32 v116, v116
    v_exp_f32 v117, v117
    v_exp_f32 v118, v118
    v_exp_f32 v119, v119
    v_cvt_pk_bf16_f32 v146, v116, v117
    v_cvt_pk_bf16_f32 v147, v118, v119
    v_mfma_f32_32x32x8_bf16 v[128:143], v[40:41], v[182:183], v[128:143]
    v_exp_f32 v120, v120
    ds_write_b128 v7, v[152:155]
    v_exp_f32 v121, v121
    ds_write_b128 v7, v[156:159] offset:1024
    v_exp_f32 v122, v122
    ds_write_b64 v217, v[160:161] offset:2048
    v_exp_f32 v123, v123
    v_cvt_pk_bf16_f32 v148, v120, v121
    v_cvt_pk_bf16_f32 v149, v122, v123
    v_mfma_f32_32x32x16_bf16 v[152:167], v[48:51], v[144:147], 0
    v_exp_f32 v124, v124
    v_exp_f32 v125, v125
    v_exp_f32 v126, v126
    v_exp_f32 v127, v127
    v_cvt_pk_bf16_f32 v150, v124, v125
    v_cvt_pk_bf16_f32 v151, v126, v127
    s_lshl_b32 s24, s12, 2
    s_add_u32 s24, s24, 160864
    v_mov_b32 v221, s24
    v_mov_b32 v222, 1
    ds_write_b32 v221, v222
    s_waitcnt vmcnt(6)
    v_mfma_f32_32x32x16_bf16 v[224:239], v[248:251], v[252:255], v[224:239]
    buffer_load_dwordx4 v[248:251], v219, s[8:11], s68 offen sc1
    buffer_load_dwordx4 v[252:255], v4, s[8:11], s69 offen offset:3072 sc1
    s_add_u32 s68, s68, 10240
    s_add_u32 s69, s69, 4096
    v_exp_f32 v128, v128
    v_exp_f32 v129, v129
    v_mfma_f32_32x32x16_bf16 v[152:167], v[52:55], v[148:151], v[152:167]
    v_exp_f32 v130, v130
    v_exp_f32 v131, v131
    v_cvt_pk_bf16_f32 v144, v128, v129
    v_cvt_pk_bf16_f32 v145, v130, v131
    v_mfma_f32_32x32x16_bf16 v[112:127], v[16:19], v[176:179], 0
    v_exp_f32 v132, v132
    v_exp_f32 v133, v133
    v_exp_f32 v134, v134
    v_exp_f32 v135, v135
    v_cvt_pk_bf16_f32 v146, v132, v133
    v_cvt_pk_bf16_f32 v147, v134, v135
    v_mfma_f32_32x32x8_bf16 v[112:127], v[42:43], v[180:181], v[112:127]
    v_exp_f32 v136, v136
    v_exp_f32 v137, v137
    v_exp_f32 v138, v138
    v_exp_f32 v139, v139
    v_cvt_pk_bf16_f32 v148, v136, v137
    v_cvt_pk_bf16_f32 v149, v138, v139
    v_mfma_f32_32x32x16_bf16 v[152:167], v[56:59], v[144:147], v[152:167]
    v_exp_f32 v140, v140
    v_exp_f32 v141, v141
    v_exp_f32 v142, v142
    v_exp_f32 v143, v143
    v_cvt_pk_bf16_f32 v150, v140, v141
    v_cvt_pk_bf16_f32 v151, v142, v143
    s_waitcnt vmcnt(6)
    v_mfma_f32_32x32x16_bf16 v[224:239], v[200:203], v[204:207], v[224:239]
    buffer_load_dwordx4 v[200:203], v219, s[8:11], s68 offen sc1
    s_sub_u32 s69, s69, s55
    buffer_load_dwordx4 v[204:207], v4, s[8:11], s69 offen offset:0 sc1
    s_add_u32 s68, s68, 10240
    s_setprio 0
    v_exp_f32 v112, v112
    v_exp_f32 v113, v113
    v_mfma_f32_32x32x16_bf16 v[152:167], v[60:63], v[148:151], v[152:167]
    v_exp_f32 v114, v114
    v_exp_f32 v115, v115
    v_cvt_pk_bf16_f32 v144, v112, v113
    v_cvt_pk_bf16_f32 v145, v114, v115
    v_mfma_f32_32x32x16_bf16 v[128:143], v[20:23], v[176:179], 0
    v_exp_f32 v116, v116
    v_exp_f32 v117, v117
    v_exp_f32 v118, v118
    v_exp_f32 v119, v119
    v_cvt_pk_bf16_f32 v146, v116, v117
    v_cvt_pk_bf16_f32 v147, v118, v119
    v_mfma_f32_32x32x8_bf16 v[128:143], v[42:43], v[182:183], v[128:143]
    v_exp_f32 v120, v120
    v_exp_f32 v121, v121
    v_exp_f32 v122, v122
    v_exp_f32 v123, v123
    v_cvt_pk_bf16_f32 v148, v120, v121
    v_cvt_pk_bf16_f32 v149, v122, v123
    v_mfma_f32_32x32x16_bf16 v[152:167], v[64:67], v[144:147], v[152:167]
    v_exp_f32 v124, v124
    v_exp_f32 v125, v125
    v_exp_f32 v126, v126
    v_exp_f32 v127, v127
    v_cvt_pk_bf16_f32 v150, v124, v125
    v_cvt_pk_bf16_f32 v151, v126, v127
    s_waitcnt vmcnt(6)
    v_mfma_f32_32x32x16_bf16 v[224:239], v[208:211], v[212:215], v[224:239]
    v_add_u32 v168, s45, v4
    v_add_u32 v169, s45, v5
    v_and_b32 v221, 7, v1
    v_lshlrev_b32 v221, 2, v221
    v_add_u32 v221, 160864, v221
    v_exp_f32 v128, v128
    v_exp_f32 v129, v129
    v_mfma_f32_32x32x16_bf16 v[152:167], v[68:71], v[148:151], v[152:167]
    v_exp_f32 v130, v130
    v_exp_f32 v131, v131
    v_cvt_pk_bf16_f32 v144, v128, v129
    v_cvt_pk_bf16_f32 v145, v130, v131
    v_mfma_f32_32x32x16_bf16 v[112:127], v[24:27], v[176:179], 0
    v_exp_f32 v132, v132
    v_exp_f32 v133, v133
    v_exp_f32 v134, v134
    v_exp_f32 v135, v135
    v_cvt_pk_bf16_f32 v146, v132, v133
    v_cvt_pk_bf16_f32 v147, v134, v135
    v_mfma_f32_32x32x8_bf16 v[112:127], v[44:45], v[180:181], v[112:127]
    v_exp_f32 v136, v136
    v_exp_f32 v137, v137
    v_exp_f32 v138, v138
    v_exp_f32 v139, v139
    v_cvt_pk_bf16_f32 v148, v136, v137
    v_cvt_pk_bf16_f32 v149, v138, v139
    v_mfma_f32_32x32x16_bf16 v[152:167], v[72:75], v[144:147], v[152:167]
    v_exp_f32 v140, v140
    v_exp_f32 v141, v141
    v_exp_f32 v142, v142
    v_exp_f32 v143, v143
    v_cvt_pk_bf16_f32 v150, v140, v141
    v_cvt_pk_bf16_f32 v151, v142, v143
    s_waitcnt vmcnt(4)
    v_mfma_f32_32x32x16_bf16 v[224:239], v[240:243], v[244:247], v[224:239]
    v_lshrrev_b32 v172, 2, v1
    v_and_b32 v173, 3, v1
    v_lshlrev_b32 v173, 4, v173
    v_mul_u32_u24 v170, 1152, v172
    v_add_u32 v170, v170, v173
    v_lshrrev_b32 v171, 1, v172
    v_mul_u32_u24 v171, 18432, v171
    v_add3_u32 v171, v171, v170, s70
    v_exp_f32 v112, v112
    v_exp_f32 v113, v113
    v_mfma_f32_32x32x16_bf16 v[152:167], v[76:79], v[148:151], v[152:167]
    v_exp_f32 v114, v114
    v_exp_f32 v115, v115
    v_cvt_pk_bf16_f32 v144, v112, v113
    v_cvt_pk_bf16_f32 v145, v114, v115
    v_mfma_f32_32x32x16_bf16 v[128:143], v[28:31], v[176:179], 0
    v_exp_f32 v116, v116
    v_exp_f32 v117, v117
    v_exp_f32 v118, v118
    v_exp_f32 v119, v119
    v_cvt_pk_bf16_f32 v146, v116, v117
    v_cvt_pk_bf16_f32 v147, v118, v119
    v_mfma_f32_32x32x8_bf16 v[128:143], v[44:45], v[182:183], v[128:143]
    v_exp_f32 v120, v120
    v_exp_f32 v121, v121
    v_exp_f32 v122, v122
    v_exp_f32 v123, v123
    v_cvt_pk_bf16_f32 v148, v120, v121
    v_cvt_pk_bf16_f32 v149, v122, v123
    v_mfma_f32_32x32x16_bf16 v[152:167], v[80:83], v[144:147], v[152:167]
    v_exp_f32 v124, v124
    v_exp_f32 v125, v125
    v_exp_f32 v126, v126
    v_exp_f32 v127, v127
    v_cvt_pk_bf16_f32 v150, v124, v125
    v_cvt_pk_bf16_f32 v151, v126, v127
    s_waitcnt vmcnt(2)
    v_mfma_f32_32x32x16_bf16 v[224:239], v[248:251], v[252:255], v[224:239]
    ds_read_b32 v222, v221
    v_exp_f32 v128, v128
    v_exp_f32 v129, v129
    v_mfma_f32_32x32x16_bf16 v[152:167], v[84:87], v[148:151], v[152:167]
    v_exp_f32 v130, v130
    v_exp_f32 v131, v131
    v_cvt_pk_bf16_f32 v144, v128, v129
    v_cvt_pk_bf16_f32 v145, v130, v131
    v_mfma_f32_32x32x16_bf16 v[112:127], v[32:35], v[176:179], 0
    v_exp_f32 v132, v132
    v_exp_f32 v133, v133
    v_exp_f32 v134, v134
    v_exp_f32 v135, v135
    v_cvt_pk_bf16_f32 v146, v132, v133
    v_cvt_pk_bf16_f32 v147, v134, v135
    v_mfma_f32_32x32x8_bf16 v[112:127], v[46:47], v[180:181], v[112:127]
    v_exp_f32 v136, v136
    v_exp_f32 v137, v137
    v_exp_f32 v138, v138
    v_exp_f32 v139, v139
    v_cvt_pk_bf16_f32 v148, v136, v137
    v_cvt_pk_bf16_f32 v149, v138, v139
    v_mfma_f32_32x32x16_bf16 v[152:167], v[88:91], v[144:147], v[152:167]
    v_exp_f32 v140, v140
    v_exp_f32 v141, v141
    v_exp_f32 v142, v142
    v_exp_f32 v143, v143
    v_cvt_pk_bf16_f32 v150, v140, v141
    v_cvt_pk_bf16_f32 v151, v142, v143
    s_waitcnt vmcnt(0)
    v_mfma_f32_32x32x16_bf16 v[224:239], v[200:203], v[204:207], v[224:239]
L_pg_c:
    s_waitcnt lgkmcnt(0)
    v_cmp_ne_u32 vcc, 1, v222
    s_nop 0
    s_cbranch_vccnz L_pg_s
    ds_read_b128 v[8:11], v168 offset:0
    ds_read_b128 v[12:15], v168 offset:1024
    ds_read_b64 v[16:17], v169 offset:2048
    ds_read_b128 v[18:21], v168 offset:2560
    ds_read_b128 v[22:25], v168 offset:3584
    ds_read_b64 v[26:27], v169 offset:4608
    ds_read_b128 v[48:51], v168 offset:5120
    ds_read_b128 v[52:55], v168 offset:6144
    ds_read_b64 v[56:57], v169 offset:7168
    ds_read_b128 v[58:61], v168 offset:7680
    ds_read_b128 v[62:65], v168 offset:8704
    ds_read_b64 v[66:67], v169 offset:9728
    ds_read_b128 v[68:71], v168 offset:10240
    ds_read_b128 v[72:75], v168 offset:11264
    ds_read_b64 v[76:77], v169 offset:12288
    ds_read_b128 v[78:81], v168 offset:12800
    ds_read_b128 v[82:85], v168 offset:13824
    ds_read_b64 v[86:87], v169 offset:14848
    v_exp_f32 v112, v112
    v_exp_f32 v113, v113
    v_mfma_f32_32x32x16_bf16 v[152:167], v[92:95], v[148:151], v[152:167]
    v_exp_f32 v114, v114
    v_exp_f32 v115, v115
    v_cvt_pk_bf16_f32 v144, v112, v113
    v_cvt_pk_bf16_f32 v145, v114, v115
    v_mfma_f32_32x32x16_bf16 v[128:143], v[36:39], v[176:179], 0
    v_exp_f32 v116, v116
    v_exp_f32 v117, v117
    v_exp_f32 v118, v118
    v_exp_f32 v119, v119
    v_cvt_pk_bf16_f32 v146, v116, v117
    v_cvt_pk_bf16_f32 v147, v118, v119
    v_mfma_f32_32x32x8_bf16 v[128:143], v[46:47], v[182:183], v[128:143]
    v_exp_f32 v120, v120
    v_exp_f32 v121, v121
    v_exp_f32 v122, v122
    v_exp_f32 v123, v123
    v_cvt_pk_bf16_f32 v148, v120, v121
    v_cvt_pk_bf16_f32 v149, v122, v123
    v_mfma_f32_32x32x16_bf16 v[152:167], v[96:99], v[144:147], v[152:167]
    v_exp_f32 v124, v124
    v_exp_f32 v125, v125
    v_exp_f32 v126, v126
    v_exp_f32 v127, v127
    v_cvt_pk_bf16_f32 v150, v124, v125
    v_cvt_pk_bf16_f32 v151, v126, v127
    s_waitcnt lgkmcnt(0)
    s_add_u32 m0, s45, 0
    s_add_u32 s47, s96, s40
    buffer_load_dwordx4 v170, s[60:63], s47 offen lds
    s_add_u32 m0, s45, 1024
    s_add_u32 s47, s97, s40
    buffer_load_dwordx4 v170, s[60:63], s47 offen lds
    s_add_u32 m0, s45, 2048
    s_add_u32 s47, s98, s40
    buffer_load_dwordx4 v170, s[60:63], s47 offen lds
    s_add_u32 m0, s45, 3072
    s_add_u32 s47, s99, s40
    buffer_load_dwordx4 v170, s[60:63], s47 offen lds
    s_add_u32 m0, s45, 4096
    s_add_u32 s47, s96, s41
    buffer_load_dwordx4 v170, s[60:63], s47 offen lds
    s_add_u32 m0, s45, 5120
    s_add_u32 s47, s97, s41
    buffer_load_dwordx4 v170, s[60:63], s47 offen lds
    s_add_u32 m0, s45, 6144
    s_add_u32 s47, s98, s41
    buffer_load_dwordx4 v170, s[60:63], s47 offen lds
    s_add_u32 m0, s45, 7168
    s_add_u32 s47, s99, s41
    buffer_load_dwordx4 v170, s[60:63], s47 offen lds
    s_cmp_ge_u32 s12, 4
    s_cbranch_scc1 L_wl_x
    s_add_u32 m0, s45, 8192
    s_add_u32 s47, s96, s42
    buffer_load_dwordx4 v170, s[60:63], s47 offen lds
    s_add_u32 m0, s45, 9216
    s_add_u32 s47, s97, s42
    buffer_load_dwordx4 v170, s[60:63], s47 offen lds
    s_add_u32 m0, s45, 10240
    s_add_u32 s47, s98, s42
    buffer_load_dwordx4 v170, s[60:63], s47 offen lds
    s_add_u32 m0, s45, 11264
    s_add_u32 s47, s99, s42
    buffer_load_dwordx4 v170, s[60:63], s47 offen lds
    s_add_u32 m0, s45, 12288
    s_add_u32 s47, s44, s40
    buffer_load_dwordx4 v171, s[60:63], s47 offen lds
    s_add_u32 m0, s45, 13312
    s_add_u32 s47, s44, s41
    buffer_load_dwordx4 v171, s[60:63], s47 offen lds
    s_add_u32 m0, s45, 14336
    s_add_u32 s47, s44, s42
    buffer_load_dwordx4 v171, s[60:63], s47 offen lds
L_wl_x:
    s_lshl_b32 s24, s12, 5
    s_add_u32 s24, s24, s45
    v_lshl_add_u32 v93, v2, 1, v3
    v_lshl_add_u32 v92, v93, 4, s24
    v_lshl_add_u32 v93, v2, 2, s24
    v_lshrrev_b32 v172, 3, v1
    v_and_b32 v173, 7, v1
    v_mul_u32_u24 v94, 17952, v173
    v_lshl_add_u32 v94, v172, 4, v94
    s_lshl_b32 s24, s12, 7
    v_add_u32 v95, s24, v94
    v_lshlrev_b32 v173, 4, v173
    v_lshl_add_u32 v174, v172, 9, v173
    v_exp_f32 v128, v128
    v_exp_f32 v129, v129
    v_mfma_f32_32x32x16_bf16 v[152:167], v[100:103], v[148:151], v[152:167]
    v_exp_f32 v130, v130
    v_exp_f32 v131, v131
    v_cvt_pk_bf16_f32 v144, v128, v129
    v_cvt_pk_bf16_f32 v145, v130, v131
    v_exp_f32 v132, v132
    v_exp_f32 v133, v133
    v_exp_f32 v134, v134
    v_exp_f32 v135, v135
    v_cvt_pk_bf16_f32 v146, v132, v133
    v_cvt_pk_bf16_f32 v147, v134, v135
    v_exp_f32 v136, v136
    v_exp_f32 v137, v137
    v_exp_f32 v138, v138
    v_exp_f32 v139, v139
    v_cvt_pk_bf16_f32 v148, v136, v137
    v_cvt_pk_bf16_f32 v149, v138, v139
    v_mfma_f32_32x32x16_bf16 v[152:167], v[104:107], v[144:147], v[152:167]
    v_exp_f32 v140, v140
    v_exp_f32 v141, v141
    v_exp_f32 v142, v142
    v_exp_f32 v143, v143
    v_cvt_pk_bf16_f32 v150, v140, v141
    v_cvt_pk_bf16_f32 v151, v142, v143
    s_waitcnt lgkmcnt(0)
    s_xor_b32 s24, s12, 7
    s_mul_i32 s24, s24, 17920
    s_add_u32 s24, s24, 31744
    v_add_u32 v7, s24, v4
    v_add_u32 v217, s24, v5
    v_mfma_f32_32x32x16_bf16 v[152:167], v[108:111], v[148:151], v[152:167]
    v_fma_f32 v184, v184, v220, v8
    v_fma_f32 v185, v185, v220, v9
    v_fma_f32 v186, v186, v220, v10
    v_fma_f32 v187, v187, v220, v11
    v_fma_f32 v188, v188, v220, v12
    v_fma_f32 v189, v189, v220, v13
    v_fma_f32 v190, v190, v220, v14
    v_fma_f32 v191, v191, v220, v15
    v_fma_f32 v192, v192, v220, v16
    v_fma_f32 v193, v193, v220, v17
    v_add_f32 v18, v18, v48
    v_add_f32 v19, v19, v49
    v_add_f32 v20, v20, v50
    ds_write_b128 v7, v[152:155]
    ds_write_b128 v7, v[156:159] offset:1024
    ds_write_b64 v217, v[160:161] offset:2048
    v_add_f32 v21, v21, v51
    v_add_f32 v22, v22, v52
    v_add_f32 v23, v23, v53
    v_add_f32 v24, v24, v54
    v_add_f32 v25, v25, v55
    v_add_f32 v26, v26, v56
    v_add_f32 v27, v27, v57
    v_add_f32 v58, v58, v68
    v_add_f32 v59, v59, v69
    v_add_f32 v60, v60, v70
    v_add_f32 v61, v61, v71
    v_add_f32 v62, v62, v72
    v_add_f32 v63, v63, v73
    v_add_f32 v64, v64, v74
    v_add_f32 v65, v65, v75
    v_add_f32 v66, v66, v76
    v_add_f32 v67, v67, v77
    s_waitcnt lgkmcnt(0)
    s_barrier
    ds_read_b128 v[112:115], v168 offset:15360
    ds_read_b128 v[116:119], v168 offset:16384
    ds_read_b64 v[120:121], v169 offset:17408
    v_add_f32 v184, v184, v78
    v_add_f32 v185, v185, v79
    v_add_f32 v186, v186, v80
    v_add_f32 v187, v187, v81
    v_add_f32 v188, v188, v82
    v_add_f32 v189, v189, v83
    v_add_f32 v190, v190, v84
    v_add_f32 v191, v191, v85
    v_add_f32 v192, v192, v86
    v_add_f32 v193, v193, v87
    v_add_f32 v18, v18, v58
    v_add_f32 v19, v19, v59
    v_add_f32 v20, v20, v60
    v_add_f32 v21, v21, v61
    v_add_f32 v22, v22, v62
    v_add_f32 v23, v23, v63
    v_add_f32 v24, v24, v64
    v_add_f32 v25, v25, v65
    v_add_f32 v26, v26, v66
    v_add_f32 v27, v27, v67
    v_add_f32 v184, v184, v18
    v_add_f32 v185, v185, v19
    v_add_f32 v186, v186, v20
    v_add_f32 v187, v187, v21
    v_add_f32 v188, v188, v22
    v_add_f32 v189, v189, v23
    v_add_f32 v190, v190, v24
    v_add_f32 v191, v191, v25
    v_add_f32 v192, v192, v26
    v_add_f32 v193, v193, v27
    s_waitcnt lgkmcnt(0)
    v_add_f32 v122, v192, v120
    v_add_f32 v123, v192, v120
    v_add_f32 v184, v184, v112
    v_add_f32 v185, v185, v113
    v_permlane32_swap_b32 v122, v123
    v_add_f32 v186, v186, v114
    v_add_f32 v187, v187, v115
    v_add_f32 v188, v188, v116
    v_rcp_f32 v124, v123
    v_add_f32 v189, v189, v117
    v_add_f32 v190, v190, v118
    v_add_f32 v191, v191, v119
    v_add_f32 v192, v192, v120
    v_add_f32 v193, v193, v121
    v_mul_f32 v184, v184, v124
    v_mul_f32 v185, v185, v124
    v_mul_f32 v186, v186, v124
    v_mul_f32 v187, v187, v124
    v_mul_f32 v188, v188, v124
    v_mul_f32 v189, v189, v124
    v_mul_f32 v190, v190, v124
    v_mul_f32 v191, v191, v124
    v_mul_f32 v192, v192, v124
    v_mul_f32 v193, v193, v124
    v_cvt_pk_bf16_f32 v144, v184, v185
    v_cvt_pk_bf16_f32 v145, v186, v187
    v_cvt_pk_bf16_f32 v146, v188, v189
    v_cvt_pk_bf16_f32 v147, v190, v191
    v_cvt_pk_bf16_f32 v148, v192, v193
    ds_write_b128 v92, v[144:147] offset:16384
    s_mov_b32 exec_hi, 0
    ds_write_b32 v93, v148 offset:17408
    s_mov_b32 exec_hi, -1
    s_waitcnt lgkmcnt(0)
    s_barrier
    ds_read_b128 v[144:147], v95 offset:32768
    ds_read_b128 v[148:151], v94 offset:33792
    v_add_f32 v118, |v184|, |v185|
    v_add_f32 v118, |v186|, v118
    v_add_f32 v118, |v187|, v118
    v_add_f32 v118, |v188|, v118
    v_add_f32 v118, |v189|, v118
    v_add_f32 v118, |v190|, v118
    v_add_f32 v118, |v191|, v118
    v_add_f32 v118, |v192|, v118
    v_add_f32 v118, |v193|, v118
    s_waitcnt lgkmcnt(0)
    buffer_store_dwordx4 v[144:147], v174, s[8:11], s29 offen sc1
    s_cmp_lg_u32 s12, 0
    s_cbranch_scc1 L_pub1
    buffer_store_dwordx4 v[148:151], v174, s[8:11], s28 offen sc1
L_pub1:
    v_mov_b32 v116, 0x71800000
    v_mov_b32 v117, 0x22800000
    v_mov_b32 v119, 0x7f800000
    v_cmp_lt_f32 s[30:31], v123, v116
    v_cmp_gt_f32 s[28:29], v123, v117
    v_cmp_lt_f32 vcc, v118, v119
    v_mov_b32 v120, 160768
    s_and_b64 s[30:31], s[30:31], s[28:29]
    s_and_b64 s[30:31], s[30:31], vcc
    s_cmp_eq_u64 s[30:31], -1
    s_cbranch_scc1 L_at_ok
    v_mov_b32 v121, 1
    ds_write_b32 v120, v121
L_at_ok:
    s_lshl_b32 s24, s12, 12
    s_add_u32 s25, s45, 12288
    s_cmp_lt_u32 s12, 4
    s_cselect_b32 s24, s24, s25
    v_lshlrev_b32 v211, 6, v3
    v_xor_b32 v211, v211, v4
    v_add_u32 v211, s24, v211
    v_xor_b32 v212, 128, v211
    ds_write_b128 v211, v[224:227] offset:0
    ds_write_b128 v212, v[228:231] offset:1024
    ds_write_b128 v211, v[232:235] offset:2048
    ds_write_b128 v212, v[236:239] offset:3072
    v_bfe_u32 v200, v1, 2, 2
    v_and_b32 v201, 1, v1
    v_bfe_u32 v202, v1, 1, 1
    v_lshl_or_b32 v201, v201, 1, v202
    v_bfe_u32 v202, v1, 4, 1
    v_lshl_or_b32 v201, v202, 2, v201
    v_lshl_add_u32 v216, v3, 3, v200
    v_lshlrev_b32 v216, 6, v216
    v_lshl_add_u32 v216, v201, 3, v216
    s_lshl_b32 s25, s12, 11
    s_add_u32 s25, s25, 106496
    v_bfe_u32 v244, v2, 1, 2
    v_xor_b32 v244, v244, v3
    v_lshlrev_b32 v244, 4, v244
    v_lshl_add_u32 v241, v2, 6, v244
    v_add_u32 v241, s25, v241
    v_add_u32 v242, s25, v4
    v_lshrrev_b32 v244, 2, v1
    v_bfe_u32 v245, v1, 3, 2
    v_xor_b32 v245, v245, v1
    v_and_b32 v245, 3, v245
    v_mul_u32_u24 v243, 2304, v244
    v_lshl_add_u32 v243, v245, 4, v243
    v_xor_b32 v244, 32, v241
    s_cmp_ge_u32 s12, 4
    s_cbranch_scc1 L_p3_hi
    s_and_b32 s40, s12, 1
    s_lshr_b32 s41, s12, 1
    s_lshl_b32 s24, s41, 12
    s_add_u32 s24, s24, 16384
    v_add_u32 v246, s24, v216
    s_add_u32 s24, s24, 53760
    v_add_u32 v247, s24, v216
    s_add_u32 s24, s24, 53760
    v_add_u32 v248, s24, v216
    s_add_u32 s24, s24, 53760
    s_lshl_b32 s24, s41, 10
    s_add_u32 s24, s24, 28672
    v_add_u32 v249, s24, v216
    s_mul_i32 s24, s40, 36864
    s_add_u32 s24, s24, 16384
    v_add_u32 v240, s24, v4
    s_lshl_b32 s46, s36, 1
    s_add_u32 s46, s46, s40
    s_mul_i32 s46, s46, 73728
    s_lshl_b32 s47, s37, 7
    s_add_u32 s46, s46, s47
    s_lshl_b32 s47, s41, 6
    s_add_u32 s46, s46, s47
    v_and_b32 v250, 7, v1
    v_lshlrev_b32 v250, 2, v250
    v_mov_b32 v252, 1
    s_mov_b32 s21, 40000
    s_waitcnt vmcnt(0) lgkmcnt(0)
    s_barrier
    ds_read_b32 v121, v120
    s_waitcnt lgkmcnt(0)
    v_readfirstlane_b32 s24, v121
    s_cmp_lg_u32 s22, 0
    s_cselect_b32 s24, 0, s24
    s_cmp_lg_u32 s24, 0
    s_cbranch_scc1 L_slow
    s_cmp_lg_u32 s12, 0
    s_cbranch_scc1 L_nf
    s_mov_b64 exec, 1
    buffer_store_dword v0, v223, s[8:11], s39 offen sc1
    s_mov_b64 exec, -1
L_nf:
    ds_read_b64_tr_b16 v[8:9], v246 offset:0
    ds_read_b64_tr_b16 v[10:11], v246 offset:256
    ds_read_b64_tr_b16 v[12:13], v246 offset:17920
    ds_read_b64_tr_b16 v[14:15], v246 offset:18176
    ds_read_b64_tr_b16 v[16:17], v246 offset:35840
    ds_read_b64_tr_b16 v[18:19], v246 offset:36096
    ds_read_b64_tr_b16 v[20:21], v247 offset:0
    ds_read_b64_tr_b16 v[22:23], v247 offset:256
    ds_read_b64_tr_b16 v[40:41], v246 offset:1024
    ds_read_b64_tr_b16 v[42:43], v246 offset:1280
    ds_read_b64_tr_b16 v[44:45], v246 offset:18944
    ds_read_b64_tr_b16 v[46:47], v246 offset:19200
    ds_read_b64_tr_b16 v[48:49], v246 offset:36864
    ds_read_b64_tr_b16 v[50:51], v246 offset:37120
    ds_read_b64_tr_b16 v[52:53], v247 offset:1024
    ds_read_b64_tr_b16 v[54:55], v247 offset:1280
    ds_read_b64_tr_b16 v[72:73], v246 offset:2048
    ds_read_b64_tr_b16 v[74:75], v246 offset:2304
    ds_read_b64_tr_b16 v[76:77], v246 offset:19968
    ds_read_b64_tr_b16 v[78:79], v246 offset:20224
    ds_read_b64_tr_b16 v[112:113], v246 offset:37888
    ds_read_b64_tr_b16 v[114:115], v246 offset:38144
    ds_read_b64_tr_b16 v[116:117], v247 offset:2048
    ds_read_b64_tr_b16 v[118:119], v247 offset:2304
    ds_read_b64_tr_b16 v[136:137], v246 offset:3072
    ds_read_b64_tr_b16 v[138:139], v246 offset:3328
    ds_read_b64_tr_b16 v[140:141], v246 offset:20992
    ds_read_b64_tr_b16 v[142:143], v246 offset:21248
    ds_read_b64_tr_b16 v[144:145], v246 offset:38912
    ds_read_b64_tr_b16 v[146:147], v246 offset:39168
    ds_read_b64_tr_b16 v[148:149], v247 offset:3072
    ds_read_b64_tr_b16 v[150:151], v247 offset:3328
    ds_read_b64_tr_b16 v[168:169], v249 offset:0
    ds_read_b64_tr_b16 v[170:171], v249 offset:256
    ds_read_b64_tr_b16 v[172:173], v249 offset:17920
    ds_read_b64_tr_b16 v[174:175], v249 offset:18176
    ds_read_b64_tr_b16 v[176:177], v249 offset:35840
    ds_read_b64_tr_b16 v[178:179], v249 offset:36096
    ds_read_b64_tr_b16 v[180:181], v249 offset:53760
    ds_read_b64_tr_b16 v[182:183], v249 offset:54016
    s_barrier
    ds_read_b64_tr_b16 v[24:25], v247 offset:17920
    ds_read_b64_tr_b16 v[26:27], v247 offset:18176
    ds_read_b64_tr_b16 v[28:29], v247 offset:35840
    ds_read_b64_tr_b16 v[30:31], v247 offset:36096
    ds_read_b64_tr_b16 v[32:33], v248 offset:0
    ds_read_b64_tr_b16 v[34:35], v248 offset:256
    ds_read_b64_tr_b16 v[36:37], v248 offset:17920
    ds_read_b64_tr_b16 v[38:39], v248 offset:18176
    ds_read_b64_tr_b16 v[56:57], v247 offset:18944
    ds_read_b64_tr_b16 v[58:59], v247 offset:19200
    ds_read_b64_tr_b16 v[60:61], v247 offset:36864
    ds_read_b64_tr_b16 v[62:63], v247 offset:37120
    ds_read_b64_tr_b16 v[64:65], v248 offset:1024
    ds_read_b64_tr_b16 v[66:67], v248 offset:1280
    ds_read_b64_tr_b16 v[68:69], v248 offset:18944
    ds_read_b64_tr_b16 v[70:71], v248 offset:19200
    ds_read_b64_tr_b16 v[120:121], v247 offset:19968
    ds_read_b64_tr_b16 v[122:123], v247 offset:20224
    ds_read_b64_tr_b16 v[124:125], v247 offset:37888
    ds_read_b64_tr_b16 v[126:127], v247 offset:38144
    ds_read_b64_tr_b16 v[128:129], v248 offset:2048
    ds_read_b64_tr_b16 v[130:131], v248 offset:2304
    ds_read_b64_tr_b16 v[132:133], v248 offset:19968
    ds_read_b64_tr_b16 v[134:135], v248 offset:20224
    ds_read_b64_tr_b16 v[152:153], v247 offset:20992
    ds_read_b64_tr_b16 v[154:155], v247 offset:21248
    ds_read_b64_tr_b16 v[156:157], v247 offset:38912
    ds_read_b64_tr_b16 v[158:159], v247 offset:39168
    ds_read_b64_tr_b16 v[160:161], v248 offset:3072
    ds_read_b64_tr_b16 v[162:163], v248 offset:3328
    ds_read_b64_tr_b16 v[164:165], v248 offset:20992
    ds_read_b64_tr_b16 v[166:167], v248 offset:21248
    s_cmp_lg_u32 s12, 1
    s_cbranch_scc1 L_poll_x
L_poll:
    buffer_load_dword v251, v250, s[8:11], s38 offen sc1
    s_waitcnt vmcnt(0)
    v_cmp_ne_u32 vcc, v0, v251
    s_sub_u32 s21, s21, 1
    s_cbranch_vccz L_poll_x
    s_sleep 1
    s_cmp_lg_u32 s21, 0
    s_cbranch_scc1 L_poll
L_poll_x:
    s_waitcnt lgkmcnt(0)
    s_barrier
    s_barrier
    ds_read_b128 v[96:99], v240 offset:0
    ds_read_b128 v[100:103], v240 offset:1024
    ds_read_b128 v[104:107], v240 offset:2048
    ds_read_b128 v[108:111], v240 offset:3072
    ds_read_b128 v[184:187], v240 offset:4096
    ds_read_b128 v[188:191], v240 offset:5120
    ds_read_b128 v[192:195], v240 offset:6144
    ds_read_b128 v[196:199], v240 offset:7168
    s_waitcnt lgkmcnt(4)
    v_mfma_f32_32x32x16_bf16 v[224:239], v[8:11], v[96:99], 0
    v_mfma_f32_32x32x16_bf16 v[224:239], v[12:15], v[100:103], v[224:239]
    v_mfma_f32_32x32x16_bf16 v[224:239], v[16:19], v[104:107], v[224:239]
    v_mfma_f32_32x32x16_bf16 v[224:239], v[20:23], v[108:111], v[224:239]
    s_barrier
    ds_read_b128 v[96:99], v240 offset:8192
    ds_read_b128 v[100:103], v240 offset:9216
    ds_read_b128 v[104:107], v240 offset:10240
    ds_read_b128 v[108:111], v240 offset:11264
    s_waitcnt lgkmcnt(4)
    v_mfma_f32_32x32x16_bf16 v[224:239], v[24:27], v[184:187], v[224:239]
    v_mfma_f32_32x32x16_bf16 v[224:239], v[28:31], v[188:191], v[224:239]
    v_mfma_f32_32x32x16_bf16 v[224:239], v[32:35], v[192:195], v[224:239]
    v_mfma_f32_32x32x16_bf16 v[224:239], v[36:39], v[196:199], v[224:239]
    ds_read_b128 v[184:187], v240 offset:12288
    ds_read_b128 v[188:191], v240 offset:13312
    ds_read_b128 v[192:195], v240 offset:14336
    ds_read_b128 v[196:199], v240 offset:15360
    s_waitcnt lgkmcnt(4)
    v_mfma_f32_32x32x16_bf16 v[224:239], v[40:43], v[96:99], v[224:239]
    v_mfma_f32_32x32x16_bf16 v[224:239], v[44:47], v[100:103], v[224:239]
    v_mfma_f32_32x32x16_bf16 v[224:239], v[48:51], v[104:107], v[224:239]
    v_mfma_f32_32x32x16_bf16 v[224:239], v[52:55], v[108:111], v[224:239]
    s_barrier
    ds_read_b128 v[96:99], v240 offset:16384
    ds_read_b128 v[100:103], v240 offset:17408
    ds_read_b128 v[104:107], v240 offset:18432
    ds_read_b128 v[108:111], v240 offset:19456
    s_waitcnt lgkmcnt(4)
    v_mfma_f32_32x32x16_bf16 v[224:239], v[56:59], v[184:187], v[224:239]
    v_mfma_f32_32x32x16_bf16 v[224:239], v[60:63], v[188:191], v[224:239]
    v_mfma_f32_32x32x16_bf16 v[224:239], v[64:67], v[192:195], v[224:239]
    v_mfma_f32_32x32x16_bf16 v[224:239], v[68:71], v[196:199], v[224:239]
    ds_read_b128 v[184:187], v240 offset:20480
    ds_read_b128 v[188:191], v240 offset:21504
    ds_read_b128 v[192:195], v240 offset:22528
    ds_read_b128 v[196:199], v240 offset:23552
    s_waitcnt lgkmcnt(4)
    v_mfma_f32_32x32x16_bf16 v[224:239], v[72:75], v[96:99], v[224:239]
    v_mfma_f32_32x32x16_bf16 v[224:239], v[76:79], v[100:103], v[224:239]
    v_mfma_f32_32x32x16_bf16 v[224:239], v[112:115], v[104:107], v[224:239]
    v_mfma_f32_32x32x16_bf16 v[224:239], v[116:119], v[108:111], v[224:239]
    s_barrier
    ds_read_b128 v[96:99], v240 offset:24576
    ds_read_b128 v[100:103], v240 offset:25600
    ds_read_b128 v[104:107], v240 offset:26624
    ds_read_b128 v[108:111], v240 offset:27648
    s_waitcnt lgkmcnt(4)
    v_mfma_f32_32x32x16_bf16 v[224:239], v[120:123], v[184:187], v[224:239]
    v_mfma_f32_32x32x16_bf16 v[224:239], v[124:127], v[188:191], v[224:239]
    v_mfma_f32_32x32x16_bf16 v[224:239], v[128:131], v[192:195], v[224:239]
    v_mfma_f32_32x32x16_bf16 v[224:239], v[132:135], v[196:199], v[224:239]
    ds_read_b128 v[184:187], v240 offset:28672
    ds_read_b128 v[188:191], v240 offset:29696
    ds_read_b128 v[192:195], v240 offset:30720
    ds_read_b128 v[196:199], v240 offset:31744
    s_waitcnt lgkmcnt(4)
    v_mfma_f32_32x32x16_bf16 v[224:239], v[136:139], v[96:99], v[224:239]
    v_mfma_f32_32x32x16_bf16 v[224:239], v[140:143], v[100:103], v[224:239]
    v_mfma_f32_32x32x16_bf16 v[224:239], v[144:147], v[104:107], v[224:239]
    v_mfma_f32_32x32x16_bf16 v[224:239], v[148:151], v[108:111], v[224:239]
    s_barrier
    ds_read_b128 v[96:99], v240 offset:32768
    ds_read_b128 v[100:103], v240 offset:33792
    ds_read_b128 v[104:107], v240 offset:34816
    ds_read_b128 v[108:111], v240 offset:35840
    s_waitcnt lgkmcnt(4)
    v_mfma_f32_32x32x16_bf16 v[224:239], v[152:155], v[184:187], v[224:239]
    v_mfma_f32_32x32x16_bf16 v[224:239], v[156:159], v[188:191], v[224:239]
    v_mfma_f32_32x32x16_bf16 v[224:239], v[160:163], v[192:195], v[224:239]
    v_mfma_f32_32x32x16_bf16 v[224:239], v[164:167], v[196:199], v[224:239]
    s_waitcnt lgkmcnt(0)
    v_mfma_f32_32x32x16_bf16 v[224:239], v[168:171], v[96:99], v[224:239]
    v_mfma_f32_32x32x16_bf16 v[224:239], v[172:175], v[100:103], v[224:239]
    v_mfma_f32_32x32x16_bf16 v[224:239], v[176:179], v[104:107], v[224:239]
    v_mfma_f32_32x32x16_bf16 v[224:239], v[180:183], v[108:111], v[224:239]
    s_cmp_ge_u32 s37, 4
    s_cbranch_scc1 L_eb_x
    s_barrier
L_eb_x:
    s_nop 11
    v_cvt_pk_bf16_f32 v8, v224, v225
    v_cvt_pk_bf16_f32 v9, v226, v227
    v_cvt_pk_bf16_f32 v10, v228, v229
    v_cvt_pk_bf16_f32 v11, v230, v231
    v_cvt_pk_bf16_f32 v12, v232, v233
    v_cvt_pk_bf16_f32 v13, v234, v235
    v_cvt_pk_bf16_f32 v14, v236, v237
    v_cvt_pk_bf16_f32 v15, v238, v239
    ds_write_b128 v241, v[8:11]
    ds_write_b128 v244, v[12:15]
    ds_read_b128 v[16:19], v242
    ds_read_b128 v[20:23], v242 offset:1024
    s_add_u32 s47, s46, 36864
    s_waitcnt lgkmcnt(1)
    buffer_store_dwordx4 v[16:19], v243, s[64:67], s46 offen nt
    s_waitcnt lgkmcnt(0)
    buffer_store_dwordx4 v[20:23], v243, s[64:67], s47 offen nt
    s_endpgm
L_p3_hi:
    v_lshrrev_b32 v212, 2, v1
    v_and_b32 v213, 3, v1
    v_lshlrev_b32 v200, 2, v213
    v_xor_b32 v200, v200, v212
    v_lshlrev_b32 v200, 4, v200
    v_lshl_add_u32 v200, v213, 9, v200
    s_lshl_b32 s24, s26, 8
    v_add_u32 v200, s24, v200
    v_add_u32 v215, 100352, v200
    s_mul_i32 s24, s18, 10
    s_sub_u32 s24, s16, s24
    s_lshl_b32 s24, s24, 6
    s_add_u32 s24, s24, s18
    s_lshl_b32 s25, s26, 5
    s_add_u32 s24, s24, s25
    v_lshl_add_u32 v201, v212, 1, s24
    v_sub_u32 v202, 1024, v201
    s_cmp_eq_u32 s19, 1
    s_cselect_b64 vcc, -1, 0
    s_cselect_b32 s29, -1.0, 1.0
    s_sub_u32 s25, 512, s19
    v_cndmask_b32 v211, v201, v202, vcc
    s_mul_i32 s24, s17, 48
    v_lshl_add_u32 v214, v213, 4, s24
    v_mul_u32_u24 v203, 2304, v211
    v_sub_u32 v204, 4718592, v203
    v_mov_b32 v205, 1073741824
    v_cmp_lt_u32 vcc, s25, v201
    v_add_u32 v206, -1, v211
    s_movk_i32 s25, 1023
    v_cmp_le_u32 s[30:31], s25, v206
    v_cmp_ne_u32 s[54:55], 3, v213
    v_cndmask_b32 v203, v203, v205, vcc
    v_cndmask_b32 v204, v204, v205, vcc
    v_cndmask_b32 v204, v204, v205, s[30:31]
    v_add_u32 v207, v203, v214
    v_add_u32 v208, v204, v214
    v_sub_u32 v206, 2288, v214
    v_add_u32 v209, v203, v206
    v_add_u32 v210, v204, v206
    s_and_b32 s34, s12, 3
    s_mul_i32 s24, s34, 17920
    s_add_u32 s24, s24, 24576
    v_add_u32 v213, s24, v216
    v_add_u32 v214, 71680, v213
    s_waitcnt vmcnt(0) lgkmcnt(0)
    s_barrier
    s_add_u32 m0, s45, 8192
    s_add_u32 s47, s96, s42
    buffer_load_dwordx4 v170, s[60:63], s47 offen lds
    s_add_u32 m0, s45, 9216
    s_add_u32 s47, s97, s42
    buffer_load_dwordx4 v170, s[60:63], s47 offen lds
    s_add_u32 m0, s45, 10240
    s_add_u32 s47, s98, s42
    buffer_load_dwordx4 v170, s[60:63], s47 offen lds
    s_add_u32 m0, s45, 11264
    s_add_u32 s47, s99, s42
    buffer_load_dwordx4 v170, s[60:63], s47 offen lds
    ds_read_b32 v121, v120
    s_waitcnt lgkmcnt(0)
    v_readfirstlane_b32 s24, v121
    s_cmp_lg_u32 s22, 0
    s_cselect_b32 s24, 0, s24
    s_cmp_lg_u32 s24, 0
    s_cbranch_scc1 L_slow
    ds_read_b128 v[8:11], v200 offset:0
    ds_read_b128 v[12:15], v200 offset:2048
    ds_read_b128 v[16:19], v200 offset:4096
    ds_read_b128 v[20:23], v200 offset:6144
    ds_read_b128 v[24:27], v200 offset:8192
    ds_read_b128 v[28:31], v200 offset:10240
    ds_read_b128 v[32:35], v200 offset:12288
    ds_read_b128 v[36:39], v200 offset:14336
    ds_read_b128 v[40:43], v215 offset:0
    ds_read_b128 v[44:47], v215 offset:2048
    ds_read_b128 v[48:51], v215 offset:17920
    ds_read_b128 v[52:55], v215 offset:19968
    ds_read_b128 v[56:59], v215 offset:35840
    ds_read_b128 v[60:63], v215 offset:37888
    ds_read_b128 v[64:67], v215 offset:53760
    ds_read_b128 v[68:71], v215 offset:55808
    s_mov_b32 s41, s34
    s_lshl_b32 s42, s36, 1
    s_and_b32 s43, s12, 1
    s_add_u32 s42, s42, s43
    s_mul_i32 s42, s42, 36864
    s_bfe_u32 s44, s12, 0x10001
    s_lshl_b32 s44, s44, 11
    s_add_u32 s42, s42, s44
    s_add_u32 s42, s42, 2621440
    s_mul_i32 s43, s43, 36864
    s_add_u32 s43, s43, s44
    s_add_u32 s43, s43, 16384
    s_add_u32 s24, s37, 0
    s_and_b32 s24, s24, 7
    s_lshl_b32 s24, s24, 12
    s_add_u32 s71, s24, s42
    s_add_u32 s24, s37, 1
    s_and_b32 s24, s24, 7
    s_lshl_b32 s24, s24, 12
    s_add_u32 s72, s24, s42
    s_add_u32 s24, s37, 2
    s_and_b32 s24, s24, 7
    s_lshl_b32 s24, s24, 12
    s_add_u32 s73, s24, s42
    s_add_u32 s24, s37, 3
    s_and_b32 s24, s24, 7
    s_lshl_b32 s24, s24, 12
    s_add_u32 s74, s24, s42
    s_add_u32 s24, s37, 4
    s_and_b32 s24, s24, 7
    s_lshl_b32 s24, s24, 12
    s_add_u32 s75, s24, s42
    s_add_u32 s24, s37, 5
    s_and_b32 s24, s24, 7
    s_lshl_b32 s24, s24, 12
    s_add_u32 s76, s24, s42
    s_add_u32 s24, s37, 6
    s_and_b32 s24, s24, 7
    s_lshl_b32 s24, s24, 12
    s_add_u32 s77, s24, s42
    s_add_u32 s24, s37, 7
    s_and_b32 s24, s24, 7
    s_lshl_b32 s24, s24, 12
    s_add_u32 s78, s24, s42
    s_add_u32 s79, s42, 32768
    s_waitcnt vmcnt(0) lgkmcnt(0)
    s_barrier
    ds_read_b64_tr_b16 v[112:113], v213 offset:0
    ds_read_b64_tr_b16 v[114:115], v213 offset:256
    ds_read_b64_tr_b16 v[116:117], v214 offset:0
    ds_read_b64_tr_b16 v[118:119], v214 offset:256
    ds_read_b64_tr_b16 v[120:121], v213 offset:1024
    ds_read_b64_tr_b16 v[122:123], v213 offset:1280
    ds_read_b64_tr_b16 v[124:125], v214 offset:1024
    ds_read_b64_tr_b16 v[126:127], v214 offset:1280
    ds_read_b64_tr_b16 v[128:129], v213 offset:2048
    ds_read_b64_tr_b16 v[130:131], v213 offset:2304
    ds_read_b64_tr_b16 v[132:133], v214 offset:2048
    ds_read_b64_tr_b16 v[134:135], v214 offset:2304
    ds_read_b64_tr_b16 v[136:137], v213 offset:3072
    ds_read_b64_tr_b16 v[138:139], v213 offset:3328
    ds_read_b64_tr_b16 v[140:141], v214 offset:3072
    ds_read_b64_tr_b16 v[142:143], v214 offset:3328
    ds_read_b64_tr_b16 v[144:145], v213 offset:6144
    ds_read_b64_tr_b16 v[146:147], v213 offset:6400
    s_and_b32 s40, s37, 1
    s_mul_i32 s24, s40, 36864
    s_lshl_b32 s25, s41, 10
    s_add_u32 s24, s24, s25
    s_add_u32 s24, s24, 16384
    v_add_u32 v240, s24, v4
    s_lshl_b32 s46, s36, 1
    s_add_u32 s46, s46, s40
    s_mul_i32 s46, s46, 73728
    s_bfe_u32 s47, s37, 0x10001
    s_lshl_b32 s47, s47, 6
    s_add_u32 s46, s46, s47
    s_add_u32 s46, s46, 1024
    v_add_f32 v8, v8, v40
    v_add_f32 v9, v9, v41
    v_add_f32 v10, v10, v42
    v_add_f32 v11, v11, v43
    v_add_f32 v12, v12, v44
    v_add_f32 v13, v13, v45
    v_add_f32 v14, v14, v46
    v_add_f32 v15, v15, v47
    v_add_f32 v16, v16, v48
    v_add_f32 v17, v17, v49
    v_add_f32 v18, v18, v50
    v_add_f32 v19, v19, v51
    v_add_f32 v20, v20, v52
    v_add_f32 v21, v21, v53
    v_add_f32 v22, v22, v54
    v_add_f32 v23, v23, v55
    v_add_f32 v24, v24, v56
    v_add_f32 v25, v25, v57
    v_add_f32 v26, v26, v58
    v_add_f32 v27, v27, v59
    v_add_f32 v28, v28, v60
    v_add_f32 v29, v29, v61
    v_add_f32 v30, v30, v62
    v_add_f32 v31, v31, v63
    v_add_f32 v32, v32, v64
    v_add_f32 v33, v33, v65
    v_add_f32 v34, v34, v66
    v_add_f32 v35, v35, v67
    v_add_f32 v36, v36, v68
    v_add_f32 v37, v37, v69
    v_add_f32 v38, v38, v70
    v_add_f32 v39, v39, v71
    s_waitcnt lgkmcnt(0)
    s_barrier
    s_add_u32 m0, s43, 0
    s_nop 0
    buffer_load_dwordx4 v4, s[8:11], s71 offen sc1 lds
    buffer_load_dwordx4 v4, s[8:11], s71 offen offset:1024 sc1 lds
    s_add_u32 m0, s43, 4096
    s_nop 0
    buffer_load_dwordx4 v4, s[8:11], s72 offen sc1 lds
    buffer_load_dwordx4 v4, s[8:11], s72 offen offset:1024 sc1 lds
    s_add_u32 m0, s43, 8192
    s_nop 0
    buffer_load_dwordx4 v4, s[8:11], s73 offen sc1 lds
    buffer_load_dwordx4 v4, s[8:11], s73 offen offset:1024 sc1 lds
    s_add_u32 m0, s43, 12288
    s_nop 0
    buffer_load_dwordx4 v4, s[8:11], s74 offen sc1 lds
    buffer_load_dwordx4 v4, s[8:11], s74 offen offset:1024 sc1 lds
    v_fma_f32 v8, v16, s29, v8
    v_fma_f32 v9, v17, s29, v9
    v_fma_f32 v10, v18, s29, v10
    v_fma_f32 v11, v19, s29, v11
    v_fma_f32 v12, v20, s29, v12
    v_fma_f32 v13, v21, s29, v13
    v_fma_f32 v14, v22, s29, v14
    v_fma_f32 v15, v23, s29, v15
    v_fma_f32 v24, v24, s29, v32
    v_fma_f32 v25, v25, s29, v33
    v_fma_f32 v26, v26, s29, v34
    v_fma_f32 v27, v27, s29, v35
    v_fma_f32 v28, v28, s29, v36
    v_fma_f32 v29, v29, s29, v37
    v_fma_f32 v30, v30, s29, v38
    v_fma_f32 v31, v31, s29, v39
    v_sub_f32 v148, v8, v24
    v_sub_f32 v149, v12, v28
    v_sub_f32 v150, v9, v25
    v_sub_f32 v151, v13, v29
    v_sub_f32 v152, v10, v26
    v_sub_f32 v153, v14, v30
    v_sub_f32 v154, v11, v27
    v_sub_f32 v155, v15, v31
    v_add_f32 v158, v8, v24
    v_add_f32 v159, v12, v28
    v_add_f32 v160, v9, v25
    v_add_f32 v161, v13, v29
    v_add_f32 v162, v10, v26
    v_add_f32 v163, v14, v30
    v_add_f32 v164, v11, v27
    v_add_f32 v165, v15, v31
    v_mov_b32_dpp v156, v148 quad_perm:[1,2,3,3] row_mask:0xf bank_mask:0xf
    v_mov_b32_dpp v166, v158 quad_perm:[1,2,3,3] row_mask:0xf bank_mask:0xf
    v_cvt_pk_bf16_f32 v80, v148, v149
    v_cvt_pk_bf16_f32 v81, v150, v151
    v_cvt_pk_bf16_f32 v82, v152, v153
    v_cvt_pk_bf16_f32 v83, v154, v155
    v_cvt_pk_bf16_f32 v84, v158, v159
    v_cvt_pk_bf16_f32 v85, v160, v161
    v_cvt_pk_bf16_f32 v86, v162, v163
    v_cvt_pk_bf16_f32 v87, v164, v165
    v_cvt_pk_bf16_f32 v88, v166, v165
    v_cvt_pk_bf16_f32 v89, v164, v163
    v_cvt_pk_bf16_f32 v90, v162, v161
    v_cvt_pk_bf16_f32 v91, v160, v159
    v_cvt_pk_bf16_f32 v92, v156, v155
    v_cvt_pk_bf16_f32 v93, v154, v153
    v_cvt_pk_bf16_f32 v94, v152, v151
    v_cvt_pk_bf16_f32 v95, v150, v149
    s_waitcnt vmcnt(4)
    s_barrier
    s_add_u32 m0, s43, 16384
    s_nop 0
    buffer_load_dwordx4 v4, s[8:11], s75 offen sc1 lds
    buffer_load_dwordx4 v4, s[8:11], s75 offen offset:1024 sc1 lds
    s_add_u32 m0, s43, 20480
    s_nop 0
    buffer_load_dwordx4 v4, s[8:11], s76 offen sc1 lds
    buffer_load_dwordx4 v4, s[8:11], s76 offen offset:1024 sc1 lds
    ds_read_b128 v[96:99], v240 offset:0
    ds_read_b128 v[184:187], v240 offset:4096
    s_waitcnt lgkmcnt(1)
    v_mfma_f32_32x32x16_bf16 v[224:239], v[112:115], v[96:99], 0
    s_waitcnt vmcnt(4)
    s_barrier
    s_add_u32 m0, s43, 24576
    s_nop 0
    buffer_load_dwordx4 v4, s[8:11], s77 offen sc1 lds
    buffer_load_dwordx4 v4, s[8:11], s77 offen offset:1024 sc1 lds
    s_add_u32 m0, s43, 28672
    s_nop 0
    buffer_load_dwordx4 v4, s[8:11], s78 offen sc1 lds
    buffer_load_dwordx4 v4, s[8:11], s78 offen offset:1024 sc1 lds
    ds_read_b128 v[96:99], v240 offset:8192
    s_waitcnt lgkmcnt(1)
    v_mfma_f32_32x32x16_bf16 v[224:239], v[116:119], v[184:187], v[224:239]
    ds_read_b128 v[184:187], v240 offset:12288
    s_waitcnt lgkmcnt(1)
    v_mfma_f32_32x32x16_bf16 v[224:239], v[120:123], v[96:99], v[224:239]
    s_waitcnt vmcnt(4)
    s_barrier
    s_add_u32 m0, s43, 32768
    s_nop 0
    buffer_load_dwordx4 v4, s[8:11], s79 offen sc1 lds
    buffer_load_dwordx4 v4, s[8:11], s79 offen offset:1024 sc1 lds
    ds_read_b128 v[96:99], v240 offset:16384
    s_waitcnt lgkmcnt(1)
    v_mfma_f32_32x32x16_bf16 v[224:239], v[124:127], v[184:187], v[224:239]
    ds_read_b128 v[184:187], v240 offset:20480
    s_waitcnt lgkmcnt(1)
    v_mfma_f32_32x32x16_bf16 v[224:239], v[128:131], v[96:99], v[224:239]
    s_waitcnt vmcnt(2)
    s_barrier
    ds_read_b128 v[96:99], v240 offset:24576
    s_waitcnt lgkmcnt(1)
    v_mfma_f32_32x32x16_bf16 v[224:239], v[132:135], v[184:187], v[224:239]
    ds_read_b128 v[184:187], v240 offset:28672
    s_waitcnt lgkmcnt(1)
    v_mfma_f32_32x32x16_bf16 v[224:239], v[136:139], v[96:99], v[224:239]
    s_waitcnt vmcnt(0)
    s_barrier
    s_cmp_eq_u32 s33, 0
    s_cbranch_scc1 L_s2s_x
    s_mov_b64 exec, s[54:55]
    buffer_store_dwordx4 v[80:83], v207, s[64:67], 0 offen offset:1152 nt
    buffer_store_dwordx4 v[84:87], v208, s[64:67], 0 offen offset:1152 nt
    buffer_store_dwordx4 v[88:91], v209, s[64:67], 0 offen nt
    buffer_store_dwordx4 v[92:95], v210, s[64:67], 0 offen nt
    s_mov_b64 exec, -1
L_s2s_x:
    ds_read_b128 v[96:99], v240 offset:32768
    s_waitcnt lgkmcnt(1)
    v_mfma_f32_32x32x16_bf16 v[224:239], v[140:143], v[184:187], v[224:239]
    s_waitcnt lgkmcnt(0)
    v_mfma_f32_32x32x16_bf16 v[224:239], v[144:147], v[96:99], v[224:239]
    s_cmp_ge_u32 s37, 4
    s_cbranch_scc1 L_at_end
    s_lshl_b32 s24, s41, 12
    s_add_u32 s24, s24, 90112
    v_add_u32 v7, s24, v4
    s_nop 8
    s_cmp_eq_u32 s12, 4
    s_cbranch_scc1 L_x4
    ds_write_b128 v7, v[224:227] offset:0
    ds_write_b128 v7, v[228:231] offset:1024
    ds_write_b128 v7, v[232:235] offset:2048
    ds_write_b128 v7, v[236:239] offset:3072
    s_waitcnt lgkmcnt(0)
    s_barrier
    s_endpgm
L_x4:
    s_barrier
    ds_read_b128 v[24:27], v7 offset:4096
    ds_read_b128 v[28:31], v7 offset:5120
    ds_read_b128 v[32:35], v7 offset:6144
    ds_read_b128 v[36:39], v7 offset:7168
    ds_read_b128 v[40:43], v7 offset:8192
    ds_read_b128 v[44:47], v7 offset:9216
    ds_read_b128 v[48:51], v7 offset:10240
    ds_read_b128 v[52:55], v7 offset:11264
    ds_read_b128 v[56:59], v7 offset:12288
    ds_read_b128 v[60:63], v7 offset:13312
    ds_read_b128 v[64:67], v7 offset:14336
    ds_read_b128 v[68:71], v7 offset:15360
    s_waitcnt lgkmcnt(8)
    v_add_f32 v224, v224, v24
    v_add_f32 v225, v225, v25
    v_add_f32 v226, v226, v26
    v_add_f32 v227, v227, v27
    v_add_f32 v228, v228, v28
    v_add_f32 v229, v229, v29
    v_add_f32 v230, v230, v30
    v_add_f32 v231, v231, v31
    v_add_f32 v232, v232, v32
    v_add_f32 v233, v233, v33
    v_add_f32 v234, v234, v34
    v_add_f32 v235, v235, v35
    v_add_f32 v236, v236, v36
    v_add_f32 v237, v237, v37
    v_add_f32 v238, v238, v38
    v_add_f32 v239, v239, v39
    s_waitcnt lgkmcnt(0)
    v_add_f32 v40, v40, v56
    v_add_f32 v41, v41, v57
    v_add_f32 v42, v42, v58
    v_add_f32 v43, v43, v59
    v_add_f32 v44, v44, v60
    v_add_f32 v45, v45, v61
    v_add_f32 v46, v46, v62
    v_add_f32 v47, v47, v63
    v_add_f32 v48, v48, v64
    v_add_f32 v49, v49, v65
    v_add_f32 v50, v50, v66
    v_add_f32 v51, v51, v67
    v_add_f32 v52, v52, v68
    v_add_f32 v53, v53, v69
    v_add_f32 v54, v54, v70
    v_add_f32 v55, v55, v71
    v_add_f32 v224, v224, v40
    v_add_f32 v225, v225, v41
    v_add_f32 v226, v226, v42
    v_add_f32 v227, v227, v43
    v_add_f32 v228, v228, v44
    v_add_f32 v229, v229, v45
    v_add_f32 v230, v230, v46
    v_add_f32 v231, v231, v47
    v_add_f32 v232, v232, v48
    v_add_f32 v233, v233, v49
    v_add_f32 v234, v234, v50
    v_add_f32 v235, v235, v51
    v_add_f32 v236, v236, v52
    v_add_f32 v237, v237, v53
    v_add_f32 v238, v238, v54
    v_add_f32 v239, v239, v55
    v_cvt_pk_bf16_f32 v8, v224, v225
    v_cvt_pk_bf16_f32 v9, v226, v227
    v_cvt_pk_bf16_f32 v10, v228, v229
    v_cvt_pk_bf16_f32 v11, v230, v231
    v_cvt_pk_bf16_f32 v12, v232, v233
    v_cvt_pk_bf16_f32 v13, v234, v235
    v_cvt_pk_bf16_f32 v14, v236, v237
    v_cvt_pk_bf16_f32 v15, v238, v239
    ds_write_b128 v241, v[8:11]
    ds_write_b128 v244, v[12:15]
    ds_read_b128 v[16:19], v242
    ds_read_b128 v[20:23], v242 offset:1024
    s_add_u32 s47, s46, 36864
    s_waitcnt lgkmcnt(1)
    buffer_store_dwordx4 v[16:19], v243, s[64:67], s46 offen nt
    s_waitcnt lgkmcnt(0)
    buffer_store_dwordx4 v[20:23], v243, s[64:67], s47 offen nt
L_at_end:
    s_endpgm
L_pg_s:
    s_sleep 1
    ds_read_b32 v222, v221
    s_branch L_pg_c
L_qs0:
    s_sleep 1
    ds_read_b32 v222, v221
    ds_read_b128 v[176:179], v6 offset:0
    ds_read_b128 v[180:183], v6 offset:1024
    s_branch L_qc0
L_qs1:
    s_sleep 1
    ds_read_b32 v222, v221
    ds_read_b128 v[168:171], v6 offset:0
    ds_read_b128 v[172:175], v6 offset:1024
    s_branch L_qc1
L_qs2:
    s_sleep 1
    ds_read_b32 v222, v221
    ds_read_b128 v[176:179], v6 offset:0
    ds_read_b128 v[180:183], v6 offset:1024
    s_branch L_qc2
L_qs3:
    s_sleep 1
    ds_read_b32 v222, v221
    ds_read_b128 v[168:171], v6 offset:0
    ds_read_b128 v[172:175], v6 offset:1024
    s_branch L_qc3
L_qs4:
    s_sleep 1
    ds_read_b32 v222, v221
    ds_read_b128 v[176:179], v6 offset:0
    ds_read_b128 v[180:183], v6 offset:1024
    s_branch L_qc4
L_qs5:
    s_sleep 1
    ds_read_b32 v222, v221
    ds_read_b128 v[176:179], v6 offset:0
    ds_read_b128 v[180:183], v6 offset:1024
    s_branch L_qc5
L_qs6:
    s_sleep 1
    ds_read_b32 v222, v221
    ds_read_b128 v[168:171], v6 offset:0
    ds_read_b128 v[172:175], v6 offset:1024
    s_branch L_qc6
L_qs7:
    s_sleep 1
    ds_read_b32 v222, v221
    ds_read_b128 v[176:179], v6 offset:0
    ds_read_b128 v[180:183], v6 offset:1024
    s_branch L_qc7
L_qs8:
    s_sleep 1
    ds_read_b32 v222, v221
    ds_read_b128 v[168:171], v6 offset:0
    ds_read_b128 v[172:175], v6 offset:1024
    s_branch L_qc8
L_qs9:
    s_sleep 1
    ds_read_b32 v222, v221
    ds_read_b128 v[176:179], v6 offset:0
    ds_read_b128 v[180:183], v6 offset:1024
    s_branch L_qc9
L_sf_s:
    s_sub_u32 s21, s21, 1
    s_cmp_eq_u32 s21, 0
    s_cbranch_scc1 L_sf_p
    s_sleep 12
    s_mov_b32 s24, 11599872
    buffer_load_dword v240, v4, s[8:11], s24 offen offset:8 sc1
    buffer_load_dword v241, v4, s[8:11], s24 offen offset:1032 sc1
    buffer_load_dword v242, v4, s[8:11], s24 offen offset:2056 sc1
    buffer_load_dword v243, v4, s[8:11], s24 offen offset:3080 sc1
    s_branch L_sf_c
L_fa_s:
    s_sub_u32 s21, s21, 1
    s_cmp_eq_u32 s21, 0
    s_cbranch_scc1 L_fa_p
    s_sleep 12
    s_mov_b32 s24, 11599872
    buffer_load_dword v240, v4, s[8:11], s24 offen offset:4 sc1
    buffer_load_dword v241, v4, s[8:11], s24 offen offset:1028 sc1
    buffer_load_dword v242, v4, s[8:11], s24 offen offset:2052 sc1
    buffer_load_dword v243, v4, s[8:11], s24 offen offset:3076 sc1
    s_branch L_fa_c
L_slow:
    s_waitcnt vmcnt(0) lgkmcnt(0)
    s_barrier
    s_mov_b32 s22, 1
    s_lshr_b32 s24, s2, 3
    s_add_u32 s25, s24, s12
    s_and_b32 s25, s25, 7
    s_lshl_b32 s25, s25, 2
    s_add_u32 s28, s25, 0
    s_lshl_b32 s71, s28, 11
    s_add_u32 s71, s71, 2359296
    s_lshl_b32 s75, s28, 8
    s_add_u32 s75, s75, 2424832
    s_mul_i32 s79, s28, 2432
    s_add_u32 s79, s79, 2433024
    s_add_u32 s28, s25, 1
    s_lshl_b32 s72, s28, 11
    s_add_u32 s72, s72, 2359296
    s_lshl_b32 s76, s28, 8
    s_add_u32 s76, s76, 2424832
    s_mul_i32 s100, s28, 2432
    s_add_u32 s100, s100, 2433024
    s_add_u32 s28, s25, 2
    s_lshl_b32 s73, s28, 11
    s_add_u32 s73, s73, 2359296
    s_lshl_b32 s77, s28, 8
    s_add_u32 s77, s77, 2424832
    s_mul_i32 s101, s28, 2432
    s_add_u32 s101, s101, 2433024
    s_add_u32 s28, s25, 3
    s_lshl_b32 s74, s28, 11
    s_add_u32 s74, s74, 2359296
    s_lshl_b32 s78, s28, 8
    s_add_u32 s78, s78, 2424832
    s_mul_i32 s3, s28, 2432
    s_add_u32 s3, s3, 2433024
    v_mul_u32_u24 v200, 36, v2
    v_lshl_add_u32 v201, v3, 4, v200
    v_lshl_add_u32 v202, v3, 30, v200
    v_mul_u32_u24 v203, 304, v3
    v_add_u32 v206, 288, v203
    v_lshl_add_u32 v203, v2, 4, v203
    v_mov_b32 v204, 1073741824
    v_cmp_gt_u32 vcc, 18, v2
    v_cmp_eq_u32 s[30:31], 20, v2
    v_lshlrev_b32 v205, 2, v2
    v_mov_b32 v40, 0x3f803f80
    v_mov_b32 v41, 0x3f803f80
    v_mov_b32 v42, 0x3f803f80
    v_mov_b32 v43, 0x3f803f80
    v_mov_b32 v44, 0x3f803f80
    v_mov_b32 v45, 0x3f803f80
    v_mov_b32 v46, 0x3f803f80
    v_mov_b32 v47, 0x3f803f80
    v_cndmask_b32 v203, v204, v203, vcc
    v_cndmask_b32 v218, v203, v206, s[30:31]
    v_mov_b32 v173, 0
    v_mov_b32 v174, 0
    v_lshlrev_b32 v209, 2, v2
    s_lshl_b32 s24, s12, 7
    s_add_u32 s24, s24, 159744
    v_add_u32 v209, s24, v209
    v_mov_b32 v210, 0xff800000
    ds_write_b32 v209, v210
    v_mov_b32 v212, 160768
    ds_write_b32 v212, v223
    s_lshl_b32 s24, s12, 2
    s_add_u32 s24, s24, 160800
    v_mov_b32 v212, s24
    ds_write_b32 v212, v223
    ds_write_b32 v212, v223 offset:64
    s_lshl_b32 s25, s12, 11
    v_add_u32 v6, s25, v4
    s_bfe_u32 s18, s2, 0x10002
    s_lshr_b32 s15, s2, 3
    s_mul_i32 s16, s18, 3
    s_sub_u32 s16, 27, s16
    s_cmp_lt_u32 s15, s16
    s_cselect_b32 s33, 1, 0
    s_cselect_b32 s15, s15, 0
    s_mul_hi_u32 s16, s15, 1431655766
    s_mul_i32 s17, s16, 3
    s_sub_u32 s17, s15, s17
    s_and_b32 s15, s2, 3
    s_mul_i32 s15, s15, 3
    s_add_u32 s17, s17, s15
    s_mul_i32 s15, s18, 10
    s_add_u32 s16, s16, s15
    s_bfe_u32 s19, s12, 0x10001
    s_and_b32 s26, s12, 1
    s_lshr_b32 s27, s12, 2
    s_lshl_b32 s68, s19, 1
    s_add_u32 s68, s68, s18
    s_lshl_b32 s68, s68, 1
    s_add_u32 s68, s68, s26
    s_mul_i32 s68, s68, 184320
    s_mul_i32 s24, s17, 192
    s_add_u32 s68, s68, s24
    s_mul_i32 s24, s27, 92160
    s_add_u32 s68, s68, s24
    s_add_u32 s68, s68, 7667712
    s_mul_i32 s69, s19, 18
    s_add_u32 s69, s69, s16
    s_lshl_b32 s69, s69, 1
    s_add_u32 s69, s69, s26
    s_mul_i32 s69, s69, 17408
    s_mul_i32 s24, s27, 9216
    s_add_u32 s69, s69, s24
    s_add_u32 s69, s69, 10289152
    s_lshr_b32 s36, s13, 6
    s_bfe_u32 s37, s13, 0x30003
    s_lshl_b32 s38, s36, 7
    s_add_u32 s38, s38, 11603968
    s_lshl_b32 s39, s37, 2
    s_add_u32 s39, s39, s38
    s_mov_b32 s60, s58
    s_mov_b32 s61, s59
    s_mov_b32 s62, 663552
    s_mov_b32 s63, 0x00020000
    s_mov_b32 s64, s6
    s_mov_b32 s65, s7
    s_mov_b32 s66, 4718592
    s_mov_b32 s67, 0x00020000
    s_mul_i32 s45, s12, 17920
    s_add_u32 s45, s45, 16384
    s_lshl_b32 s40, s37, 7
    s_add_u32 s41, s40, 64
    s_bfe_u32 s42, s37, 0x10001
    s_lshl_b32 s42, s42, 6
    s_add_u32 s42, s42, 1024
    s_lshl_b32 s43, s37, 2
    s_add_u32 s43, s43, s12
    s_add_u32 s24, s43, 0
    s_and_b32 s24, s24, 31
    s_mul_i32 s96, s24, 20736
    s_add_u32 s24, s43, 8
    s_and_b32 s24, s24, 31
    s_mul_i32 s97, s24, 20736
    s_add_u32 s24, s43, 16
    s_and_b32 s24, s24, 31
    s_mul_i32 s98, s24, 20736
    s_add_u32 s24, s43, 24
    s_and_b32 s24, s24, 31
    s_mul_i32 s99, s24, 20736
    s_mul_i32 s44, s12, 165888
    s_lshr_b32 s28, s13, 5
    s_mul_i32 s28, s28, 36864
    s_and_b32 s29, s13, 31
    s_lshl_b32 s29, s29, 4
    s_add_u32 s28, s28, s29
    s_add_u32 s28, s28, 2621440
    s_lshl_b32 s29, s12, 12
    s_add_u32 s29, s29, s28
    s_add_u32 s28, s28, 32768
    s_mov_b32 s70, 18432
    s_waitcnt lgkmcnt(0)
    s_setprio 3
    buffer_load_dwordx4 v[168:171], v201, s[8:11], s14 offen sc1
    buffer_load_dword v172, v202, s[8:11], s14 offen offset:32 sc1
    buffer_load_dwordx4 v[8:11], v4, s[8:11], s71 offen offset:0 sc1
    buffer_load_dwordx4 v[12:15], v4, s[8:11], s71 offen offset:1024 sc1
    buffer_load_dwordx4 v[16:19], v4, s[8:11], s72 offen offset:0 sc1
    buffer_load_dwordx4 v[20:23], v4, s[8:11], s72 offen offset:1024 sc1
    buffer_load_dwordx4 v[24:27], v4, s[8:11], s73 offen offset:0 sc1
    buffer_load_dwordx4 v[28:31], v4, s[8:11], s73 offen offset:1024 sc1
    buffer_load_dwordx4 v[32:35], v4, s[8:11], s74 offen offset:0 sc1
    buffer_load_dwordx4 v[36:39], v4, s[8:11], s74 offen offset:1024 sc1
    s_mov_b32 exec_hi, 0
    buffer_load_dword v40, v205, s[8:11], s75 offen offset:0 sc1
    buffer_load_dword v41, v205, s[8:11], s75 offen offset:128 sc1
    buffer_load_dword v42, v205, s[8:11], s76 offen offset:0 sc1
    buffer_load_dword v43, v205, s[8:11], s76 offen offset:128 sc1
    buffer_load_dword v44, v205, s[8:11], s77 offen offset:0 sc1
    buffer_load_dword v45, v205, s[8:11], s77 offen offset:128 sc1
    buffer_load_dword v46, v205, s[8:11], s78 offen offset:0 sc1
    buffer_load_dword v47, v205, s[8:11], s78 offen offset:128 sc1
    s_mov_b32 exec_hi, -1
    buffer_load_dwordx4 v[48:51], v218, s[8:11], s79 offen offset:0 sc1
    buffer_load_dwordx4 v[52:55], v218, s[8:11], s79 offen offset:608 sc1
    buffer_load_dwordx4 v[56:59], v218, s[8:11], s79 offen offset:1216 sc1
    buffer_load_dwordx4 v[60:63], v218, s[8:11], s79 offen offset:1824 sc1
    buffer_load_dwordx4 v[64:67], v218, s[8:11], s100 offen offset:0 sc1
    buffer_load_dwordx4 v[68:71], v218, s[8:11], s100 offen offset:608 sc1
    buffer_load_dwordx4 v[72:75], v218, s[8:11], s100 offen offset:1216 sc1
    buffer_load_dwordx4 v[76:79], v218, s[8:11], s100 offen offset:1824 sc1
    buffer_load_dwordx4 v[80:83], v218, s[8:11], s101 offen offset:0 sc1
    buffer_load_dwordx4 v[84:87], v218, s[8:11], s101 offen offset:608 sc1
    buffer_load_dwordx4 v[88:91], v218, s[8:11], s101 offen offset:1216 sc1
    buffer_load_dwordx4 v[92:95], v218, s[8:11], s101 offen offset:1824 sc1
    buffer_load_dwordx4 v[96:99], v218, s[8:11], s3 offen offset:0 sc1
    buffer_load_dwordx4 v[100:103], v218, s[8:11], s3 offen offset:608 sc1
    buffer_load_dwordx4 v[104:107], v218, s[8:11], s3 offen offset:1216 sc1
    buffer_load_dwordx4 v[108:111], v218, s[8:11], s3 offen offset:1824 sc1
    s_waitcnt vmcnt(0)
    v_mov_b32 v175, v172
    ds_write_b128 v6, v[168:171] offset:0
    ds_write_b128 v6, v[172:175] offset:1024
    s_waitcnt lgkmcnt(0)
    s_barrier
    s_mov_b32 s21, 0
L_ex_loop:
    s_lshl_b32 s24, s21, 11
    v_add_u32 v7, s24, v4
    ds_read_b128 v[176:179], v7 offset:0
    ds_read_b128 v[180:183], v7 offset:1024
    s_waitcnt lgkmcnt(0)
    v_mfma_f32_32x32x16_bf16 v[112:127], v[8:11], v[176:179], 0
    v_mfma_f32_32x32x8_bf16 v[112:127], v[40:41], v[180:181], v[112:127]
    s_nop 11
    v_max3_f32 v209, v112, v113, v114
    v_max3_f32 v210, v115, v116, v117
    v_max3_f32 v211, v118, v119, v120
    v_max3_f32 v212, v121, v122, v123
    v_max3_f32 v213, v124, v125, v126
    v_max3_f32 v209, v209, v210, v127
    v_max3_f32 v211, v211, v212, v213
    v_max_f32 v214, v209, v211
    v_mfma_f32_32x32x16_bf16 v[112:127], v[12:15], v[176:179], 0
    v_mfma_f32_32x32x8_bf16 v[112:127], v[40:41], v[182:183], v[112:127]
    s_nop 11
    v_max3_f32 v209, v112, v113, v114
    v_max3_f32 v210, v115, v116, v117
    v_max3_f32 v211, v118, v119, v120
    v_max3_f32 v212, v121, v122, v123
    v_max3_f32 v213, v124, v125, v126
    v_max3_f32 v209, v209, v210, v127
    v_max3_f32 v211, v211, v212, v213
    v_max3_f32 v214, v209, v211, v214
    v_mfma_f32_32x32x16_bf16 v[112:127], v[16:19], v[176:179], 0
    v_mfma_f32_32x32x8_bf16 v[112:127], v[42:43], v[180:181], v[112:127]
    s_nop 11
    v_max3_f32 v209, v112, v113, v114
    v_max3_f32 v210, v115, v116, v117
    v_max3_f32 v211, v118, v119, v120
    v_max3_f32 v212, v121, v122, v123
    v_max3_f32 v213, v124, v125, v126
    v_max3_f32 v209, v209, v210, v127
    v_max3_f32 v211, v211, v212, v213
    v_max3_f32 v214, v209, v211, v214
    v_mfma_f32_32x32x16_bf16 v[112:127], v[20:23], v[176:179], 0
    v_mfma_f32_32x32x8_bf16 v[112:127], v[42:43], v[182:183], v[112:127]
    s_nop 11
    v_max3_f32 v209, v112, v113, v114
    v_max3_f32 v210, v115, v116, v117
    v_max3_f32 v211, v118, v119, v120
    v_max3_f32 v212, v121, v122, v123
    v_max3_f32 v213, v124, v125, v126
    v_max3_f32 v209, v209, v210, v127
    v_max3_f32 v211, v211, v212, v213
    v_max3_f32 v214, v209, v211, v214
    v_mfma_f32_32x32x16_bf16 v[112:127], v[24:27], v[176:179], 0
    v_mfma_f32_32x32x8_bf16 v[112:127], v[44:45], v[180:181], v[112:127]
    s_nop 11
    v_max3_f32 v209, v112, v113, v114
    v_max3_f32 v210, v115, v116, v117
    v_max3_f32 v211, v118, v119, v120
    v_max3_f32 v212, v121, v122, v123
    v_max3_f32 v213, v124, v125, v126
    v_max3_f32 v209, v209, v210, v127
    v_max3_f32 v211, v211, v212, v213
    v_max3_f32 v214, v209, v211, v214
    v_mfma_f32_32x32x16_bf16 v[112:127], v[28:31], v[176:179], 0
    v_mfma_f32_32x32x8_bf16 v[112:127], v[44:45], v[182:183], v[112:127]
    s_nop 11
    v_max3_f32 v209, v112, v113, v114
    v_max3_f32 v210, v115, v116, v117
    v_max3_f32 v211, v118, v119, v120
    v_max3_f32 v212, v121, v122, v123
    v_max3_f32 v213, v124, v125, v126
    v_max3_f32 v209, v209, v210, v127
    v_max3_f32 v211, v211, v212, v213
    v_max3_f32 v214, v209, v211, v214
    v_mfma_f32_32x32x16_bf16 v[112:127], v[32:35], v[176:179], 0
    v_mfma_f32_32x32x8_bf16 v[112:127], v[46:47], v[180:181], v[112:127]
    s_nop 11
    v_max3_f32 v209, v112, v113, v114
    v_max3_f32 v210, v115, v116, v117
    v_max3_f32 v211, v118, v119, v120
    v_max3_f32 v212, v121, v122, v123
    v_max3_f32 v213, v124, v125, v126
    v_max3_f32 v209, v209, v210, v127
    v_max3_f32 v211, v211, v212, v213
    v_max3_f32 v214, v209, v211, v214
    v_mfma_f32_32x32x16_bf16 v[112:127], v[36:39], v[176:179], 0
    v_mfma_f32_32x32x8_bf16 v[112:127], v[46:47], v[182:183], v[112:127]
    s_nop 11
    v_max3_f32 v209, v112, v113, v114
    v_max3_f32 v210, v115, v116, v117
    v_max3_f32 v211, v118, v119, v120
    v_max3_f32 v212, v121, v122, v123
    v_max3_f32 v213, v124, v125, v126
    v_max3_f32 v209, v209, v210, v127
    v_max3_f32 v211, v211, v212, v213
    v_max3_f32 v214, v209, v211, v214
    v_mov_b32 v215, v214
    s_nop 1
    v_permlane32_swap_b32 v214, v215
    s_nop 1
    v_max_f32 v214, v214, v215
    s_lshl_b32 s24, s21, 7
    s_add_u32 s24, s24, 159744
    v_lshlrev_b32 v206, 2, v2
    v_add_u32 v206, s24, v206
    ds_max_f32 v206, v214
    s_add_u32 s21, s21, 1
    s_cmp_lt_u32 s21, 8
    s_cbranch_scc1 L_ex_loop
    s_waitcnt lgkmcnt(0)
    s_barrier
    s_lshl_b32 s24, s12, 7
    s_add_u32 s24, s24, 159744
    v_lshlrev_b32 v206, 2, v2
    v_add_u32 v206, s24, v206
    ds_read_b32 v207, v206
    s_waitcnt lgkmcnt(0)
    v_xor_b32 v207, 0x80000000, v207
    v_and_b32 v208, 0xffff0000, v207
    v_sub_f32 v207, v207, v208
    v_and_b32 v209, 0xffff0000, v207
    v_sub_f32 v207, v207, v209
    v_lshrrev_b32 v208, 16, v208
    v_or_b32 v208, v208, v209
    v_lshrrev_b32 v207, 16, v207
    v_cmp_eq_u32 vcc, 1, v3
    s_nop 1
    v_cndmask_b32 v172, v172, v208, vcc
    v_cndmask_b32 v175, v175, v208, vcc
    v_cndmask_b32 v173, v173, v207, vcc
    v_cndmask_b32 v174, v174, v207, vcc
    s_nop 1
    s_branch L_at_main
L_code_end:
.section .rodata,"a"
.p2align 6
.amdhsa_kernel concat_heads__grouped_kv_mqa__spectral_fnet__prompt_kernel
  .amdhsa_next_free_vgpr 256
  .amdhsa_next_free_sgpr 102
  .amdhsa_accum_offset 256
  .amdhsa_group_segment_fixed_size 0
  .amdhsa_kernarg_size 104
  .amdhsa_user_sgpr_count 2
  .amdhsa_user_sgpr_kernarg_segment_ptr 1
  .amdhsa_system_sgpr_workgroup_id_x 1
.end_amdhsa_kernel
```
